```python
import torch

def _softmax(x, axis=-1):
    return torch.softmax(x, dim=axis)
def _gelu(x):
    return torch.nn.functional.gelu(x, approximate="tanh")
def _silu(x):
    return torch.nn.functional.silu(x)
def _sigmoid(x):
    return torch.sigmoid(x)
def _layernorm(x, axis=-1, eps=1e-5):
    m = x.mean(dim=axis, keepdim=True)
    v = x.var(dim=axis, keepdim=True, unbiased=False)
    return (x - m) / torch.sqrt(v + eps)
def _scatter_add(tgt, idx, src, axis=0):
    return tgt.clone().index_add_(axis, idx, src)
def _segment_sum(src, seg, n):
    out = torch.zeros((n,) + src.shape[1:], dtype=src.dtype)
    return out.index_add_(0, seg, src)
def _pad(x, pw):
    flat = tuple(v for pair in reversed(pw) for v in pair)
    return torch.nn.functional.pad(x, flat)

kernel_name = 'concat_heads__ssm_conv_s4__ssm_conv_h3__prompt'

def setup_inputs():

    _w = (lambda a: (lambda t: t.to(torch.bfloat16) if t.is_floating_point() else t)(torch.as_tensor(a)))
    def _A_setup():
        B, L, D, N = 1, 2048, 1024, 128
        A_re = -(lambda _x: torch.exp(torch.as_tensor(_x)))((lambda *s: torch.randn(*s, dtype=torch.bfloat16) * 3.2)(D, N))
        A_im = torch.pi * (lambda *s: torch.randn(*s, dtype=torch.bfloat16) * 0.05)(D, N)
        B_re = (lambda *s: torch.randn(*s, dtype=torch.bfloat16) * 0.1)(D, N)
        B_im = (lambda *s: torch.randn(*s, dtype=torch.bfloat16) * 0.1)(D, N)
        C_re = (lambda *s: torch.randn(*s, dtype=torch.bfloat16) * 0.1)(D, N)
        C_im = (lambda *s: torch.randn(*s, dtype=torch.bfloat16) * 0.1)(D, N)
        log_dt = (lambda *s: torch.randn(*s, dtype=torch.bfloat16) * 0.05)(D) * 0.5 - 4.0
        Dskip = (lambda *s: torch.randn(*s, dtype=torch.bfloat16) * 0.05)(D)
        return {
            "u": _w((lambda *s: torch.randn(*s, dtype=torch.bfloat16) * 0.05)(B, L, D)),
            "A_re": _w(A_re),
            "A_im": _w(A_im),
            "B_re": _w(B_re),
            "B_im": _w(B_im),
            "C_re": _w(C_re),
            "C_im": _w(C_im),
            "log_dt": _w(log_dt),
            "Dskip": _w(Dskip),
        }
    _A_in = _A_setup()

    def _B_setup():
        B, S, D = 1, 2048, 1024
        ks = 4
        return {
            "q": _w((lambda *s: torch.randn(*s, dtype=torch.bfloat16) * 0.05)(B, S, D)),
            "k": _w((lambda *s: torch.randn(*s, dtype=torch.bfloat16) * 0.2)(B, S, D)),
            "v": _w((lambda *s: torch.randn(*s, dtype=torch.bfloat16) * 0.2)(B, S, D)),
            "shift_k": _w((lambda *s: torch.randn(*s, dtype=torch.bfloat16) * 0.2)(D, ks) * 0.5),
            "ssm_k": _w((lambda *s: torch.randn(*s, dtype=torch.bfloat16) * 0.8)(D, S) * (1.0 / S ** 0.5)),
            "ssm_D": _w((lambda *s: torch.randn(*s, dtype=torch.bfloat16) * 0.2)(D)),
        }
    _B_in = _B_setup()

    return {
        "A_u": _A_in["u"],
        "A_A_re": _A_in["A_re"],
        "A_A_im": _A_in["A_im"],
        "A_B_re": _A_in["B_re"],
        "A_B_im": _A_in["B_im"],
        "A_C_re": _A_in["C_re"],
        "A_C_im": _A_in["C_im"],
        "A_log_dt": _A_in["log_dt"],
        "A_Dskip": _A_in["Dskip"],
        "B_q": _B_in["q"],
        "B_k": _B_in["k"],
        "B_v": _B_in["v"],
        "B_shift_k": _B_in["shift_k"],
        "B_ssm_k": _B_in["ssm_k"],
        "B_ssm_D": _B_in["ssm_D"],
    }

def reference(A_u, A_A_re, A_A_im, A_B_re, A_B_im, A_C_re, A_C_im, A_log_dt, A_Dskip, B_q, B_k, B_v, B_shift_k, B_ssm_k, B_ssm_D):
    def _A_ref(u, A_re, A_im, B_re, B_im, C_re, C_im, log_dt, Dskip):
        Bsz, L, D = u.shape
        dt = torch.exp(log_dt)[:, None]
        A = A_re + 1j * A_im
        Bc = B_re + 1j * B_im
        Cc = C_re + 1j * C_im
        logdA = dt * A
        dB = dt * Bc
        l = (lambda x, dt: x.to(dt))(torch.arange(L), A_re.dtype)
        P = torch.exp(logdA[:, :, None] * l[None, None, :])
        K = torch.einsum("dn,dnl,dn->dl", Cc, P, dB).real
        L2 = 2 * L
        Kp = _pad(K, ((0, 0), (0, L)))
        up = (lambda x, *d: x.permute(*d))(u, 0, 2, 1)
        up = _pad(up, ((0, 0), (0, 0), (0, L)))
        Kf = (lambda x, axes=(-2,-1): torch.fft.rfft2(x.float(), dim=axes))(Kp[:, None, :], axes=(-2, -1))
        Uf = (lambda x, axes=(-2,-1): torch.fft.rfft2(x.float(), dim=axes))(up[:, :, None, :], axes=(-2, -1))
        Yf = Uf * Kf[None, :, :, :]
        y = (lambda x, s, axes=(-2,-1): torch.fft.irfft2(x, s=s, dim=axes).to(torch.bfloat16))(Yf, (1, L2), axes=(-2, -1))[:, :, 0, :L]
        y = (lambda x, *d: x.permute(*d))(y, 0, 2, 1) + u * Dskip[None, None, :]
        return y

    def _B_ref(q, k, v, shift_k, ssm_k, ssm_D):
        B, S, D = q.shape
        ks = shift_k.shape[-1]
        k_pad = _pad(k, ((0, 0), (ks - 1, 0), (0, 0)))
        k_shift = torch.zeros_like(k)
        for t in range(ks):
            k_shift = k_shift + k_pad[:, t:t + S, :] * shift_k[:, ks - 1 - t][None, None, :]
        kv = k_shift * v
        L = 2 * S
        kv_pad = _pad(kv, ((0, 0), (0, S), (0, 0)))
        kf_pad = _pad(ssm_k, ((0, 0), (0, S)))
        kv_f = (lambda x, axes=(-2,-1): torch.fft.rfft2(x.float(), dim=axes))(kv_pad[:, None, :, :], axes=(1, 2))
        kf_f = (lambda x, axes=(-2,-1): torch.fft.rfft2(x.float(), dim=axes))(kf_pad[:, None, :], axes=(1, 2))
        kf_f = (lambda x, *d: x.permute(*d))(kf_f, 1, 2, 0)
        y_f = kv_f * kf_f[None, :, :, :]
        y = (lambda x, s, axes=(-2,-1): torch.fft.irfft2(x, s=s, dim=axes).to(torch.bfloat16))(y_f, (1, L), axes=(1, 2))[:, 0, :S, :]
        y = y + kv * ssm_D[None, None, :]
        return q * y

    a = _A_ref(A_u, A_A_re, A_A_im, A_B_re, A_B_im, A_C_re, A_C_im, A_log_dt, A_Dskip)
    b = _B_ref(B_q, B_k, B_v, B_shift_k, B_ssm_k, B_ssm_D)
    return torch.concatenate([a, b], axis=-1)
```

```asm
; @launch grid=(256,1,1) block=(512,1,1) lds=160384
.amdgcn_target "amdgcn-amd-amdhsa--gfx950"
.text
.globl concat_heads__ssm_conv_s4__ssm_conv_h3__prompt_kernel
.p2align 8
.type concat_heads__ssm_conv_s4__ssm_conv_h3__prompt_kernel,@function
concat_heads__ssm_conv_s4__ssm_conv_h3__prompt_kernel:
    s_load_dwordx16 s[8:23], s[0:1], 0
    s_load_dwordx16 s[24:39], s[0:1], 64
    s_cmp_ge_u32 s2, 256
    s_cbranch_scc1 L_exit
    v_lshrrev_b32 v12, 6, v0
    v_and_b32 v11, 63, v0
    s_bfe_u32 s5, s2, 0x30003
    v_readfirstlane_b32 s4, v12
    s_getpc_b64 s[40:41]
L_pc:
    s_and_b32 s42, s2, 0xf8
    s_add_u32 s42, s42, s4
    s_lshl_b32 s42, s42, 7
    s_min_u32 s42, s42, L_exit-L_pc
    s_add_u32 s40, s40, s42
    s_addc_u32 s41, s41, 0
    v_mov_b32 v14, s40
    v_mov_b32 v15, s41
    global_load_dword v62, v[14:15], off
    s_lshl_b32 s46, s2, 2
    s_lshr_b32 s46, 0x76043215, s46
    s_and_b32 s46, s46, 7
    s_lshl_b32 s46, s46, 7
    s_bfe_u32 s47, s2, 0x10007
    s_lshl_b32 s47, s47, 6
    s_add_u32 s6, s46, s47
    s_lshl_b32 s46, s5, 3
    s_add_u32 s6, s6, s46
    s_add_u32 s3, s6, s4
    s_lshr_b32 s45, s4, 2
    s_mov_b32 s7, s4
    s_lshl_b32 s47, s3, 1
    v_mov_b32 v17, s47
    s_bitcmp1_b32 s2, 6
    s_cbranch_scc1 L_A
    s_mul_i32 s44, s4, 17872
    s_lshl_b32 s46, s3, 12
    v_lshl_add_u32 v10, v11, 4, s46
    v_mov_b32 v16, s46
    s_mov_b32 s54, 0x400000
    s_mov_b32 s55, 0x20000
    s_waitcnt lgkmcnt(0)
    s_mov_b32 s52, s34
    s_mov_b32 s53, s35
    s_add_u32 m0, s44, 64
    s_nop 0
    buffer_load_dwordx4 v10, s[52:55], 0 offen offset:0 lds
    buffer_load_dwordx4 v10, s[52:55], 0 offen offset:1024 lds
    global_load_dword v76, v16, s[34:35]
    global_load_ushort v77, v17, s[36:37]
    s_branch L_B
L_A:
    s_mov_b32 s43, s6
    s_lshl_b32 s46, s2, 2
    s_lshr_b32 s46, 0x76543210, s46
    s_and_b32 s46, s46, 7
    s_lshl_b32 s46, s46, 6
    s_and_b32 s47, s43, 64
    s_lshl_b32 s47, s47, 3
    s_add_u32 s46, s46, s47
    s_and_b32 s47, s43, 56
    s_add_u32 s6, s46, s47
    s_add_u32 s3, s6, s4
    s_lshl_b32 s47, s3, 1
    v_mov_b32 v17, s47
    s_lshl_b32 s46, s3, 8
    v_lshl_add_u32 v16, v11, 2, s46
    s_bfe_u32 s46, s2, 0x10007
    s_lshl_b32 s46, s46, 3
    s_add_u32 s46, s46, s5
    s_lshl_b32 s46, s46, 16
    s_and_b32 s47, s43, 0x380
    s_lshl_b32 s47, s47, 1
    s_add_u32 s46, s46, s47
    v_lshrrev_b32 v20, 4, v0
    v_lshl_add_u32 v20, v20, 11, s46
    v_and_b32 v13, 8, v0
    v_lshl_add_u32 v20, v13, 4, v20
    s_waitcnt lgkmcnt(0)
    global_load_ushort v118, v17, s[22:23]
    global_load_dword v112, v16, s[10:11]
    global_load_dword v113, v16, s[12:13]
    global_load_dword v114, v16, s[14:15]
    global_load_dword v115, v16, s[16:17]
    global_load_dword v116, v16, s[18:19]
    global_load_dword v117, v16, s[20:21]
    global_load_ushort v119, v17, s[24:25]
    global_load_dword v10, v20, s[28:29]
    global_load_dword v10, v20, s[30:31]
    v_add_u32 v21, 0x100000, v20
    v_add_u32 v22, 0x200000, v20
    v_add_u32 v23, 0x300000, v20
    v_and_b32 v122, 0xfffff800, v20
    v_lshl_add_u32 v122, v13, 7, v122
    s_and_b32 s47, s6, 0x1c0
    s_lshl_b32 s47, s47, 1
    v_add_u32 v122, s47, v122
    v_add_u32 v123, 0x100000, v122
    v_add_u32 v124, 0x200000, v122
    v_add_u32 v125, 0x300000, v122
    s_lshl_b32 s46, s7, 17
    s_lshl_b32 s47, s6, 1
    s_add_u32 s46, s46, s47
    s_add_u32 s46, s46, 4096
    v_lshrrev_b32 v12, 2, v11
    v_and_b32 v13, 3, v11
    v_lshlrev_b32 v14, 13, v12
    v_lshl_add_u32 v14, v13, 2, v14
    v_add_u32 v6, s46, v14
    s_mul_i32 s44, s4, 15424
    s_add_u32 s44, s44, 36992
    v_mul_u32_u24 v14, 9248, v13
    v_lshlrev_b32 v12, 3, v12
    v_sub_u32 v14, v14, v12
    s_lshl_b32 s46, s7, 7
    s_sub_u32 s46, 4088, s46
    v_add_u32 v3, s46, v14
    s_mul_i32 s46, s4, 15424
    s_add_u32 s46, s46, 41152
    v_lshl_add_u32 v4, v11, 3, s46
    s_lshl_b32 s46, s4, 7
    s_add_u32 s46, s46, 40640
    v_bfe_u32 v78, v11, 2, 2
    v_mul_u32_u24 v78, 15424, v78
    v_lshrrev_b32 v79, 4, v11
    v_lshl_add_u32 v78, v79, 5, v78
    v_and_b32 v79, 3, v11
    v_lshl_add_u32 v78, v79, 3, v78
    v_add_u32 v5, s46, v78
    s_lshl_b32 s46, s4, 6
    s_and_b32 s46, s46, 0x100
    s_and_b32 s47, s4, 3
    s_lshl_b32 s47, s47, 2
    s_add_u32 s46, s46, s47
    v_lshrrev_b32 v78, 2, v11
    v_lshl_add_u32 v78, v78, 4, v79
    v_add_u32 v78, s46, v78
    s_lshl_b32 s47, s6, 1
    v_lshl_add_u32 v9, v78, 12, s47
    s_mov_b32 s48, 0x05040100
    s_mov_b32 s49, 0x07060302
    s_mov_b32 m0, s44
    v_and_b32 v76, 15, v11
    v_and_b32 v77, 48, v11
    v_lshl_add_u32 v78, v76, 1, v77
    v_add_u32 v78, 2, v78
    v_and_b32 v79, 2, v78
    v_mul_u32_u24 v79, 607, v79
    v_add3_u32 v7, v78, v79, s44
    v_add_u32 v8, 1024, v7
    v_lshl_add_u32 v84, v11, 1, s44
    v_mov_b32 v78, 0x3f80
    s_mov_b32 vcc_hi, 0
    s_mov_b32 vcc_lo, 0x1ff00000
    v_cndmask_b32 v88, 0, v78, vcc
    s_mov_b32 vcc_lo, 0xfe00000
    v_cndmask_b32 v89, 0, v78, vcc
    s_mov_b32 vcc_lo, 0x7c00000
    v_cndmask_b32 v90, 0, v78, vcc
    s_mov_b32 vcc_lo, 0x380000
    v_cndmask_b32 v91, 0, v78, vcc
    s_mov_b32 vcc_lo, 0x180000
    v_cndmask_b32_e64 v92, 0, -1, vcc
    s_mov_b32 vcc_lo, 0x70000
    v_cndmask_b32_e64 v93, 0, -1, vcc
    ds_write_b16 v84, v88 offset:0
    ds_write_b16 v84, v88 offset:1214
    ds_write_b16 v84, v89 offset:128
    ds_write_b16 v84, v89 offset:1342
    ds_write_b16 v84, v90 offset:256
    ds_write_b16 v84, v90 offset:1470
    ds_write_b16 v84, v91 offset:384
    ds_write_b16 v84, v91 offset:1598
    ds_write_b16 v84, v92 offset:512
    ds_write_b16 v84, v92 offset:1726
    ds_write_b16 v84, v93 offset:640
    ds_write_b16 v84, v93 offset:1854
    ds_read2_b32 v[28:29], v7 offset0:0 offset1:1
    ds_read2_b32 v[30:31], v7 offset0:2 offset1:3
    ds_read2_b32 v[32:33], v7 offset0:32 offset1:33
    ds_read2_b32 v[34:35], v7 offset0:34 offset1:35
    ds_read2_b32 v[36:37], v7 offset0:64 offset1:65
    ds_read2_b32 v[38:39], v7 offset0:66 offset1:67
    ds_read2_b32 v[40:41], v7 offset0:96 offset1:97
    ds_read2_b32 v[42:43], v7 offset0:98 offset1:99
    ds_read2_b32 v[44:45], v7 offset0:128 offset1:129
    ds_read2_b32 v[46:47], v7 offset0:130 offset1:131
    ds_read2_b32 v[48:49], v7 offset0:160 offset1:161
    ds_read2_b32 v[50:51], v7 offset0:162 offset1:163
    ds_write_addtid_b32 v78 offset:2304
    s_mul_i32 s46, s4, 4624
    s_add_u32 s47, s46, 480
    v_lshlrev_b32 v79, 5, v76
    v_sub_u32 v79, v77, v79
    v_add_u32 v2, s47, v79
    v_mov_b32 v92, 0
    v_mov_b32 v93, 0
    v_mov_b32 v94, 0
    v_mov_b32 v95, 0
    v_min_u32 v79, 29, v11
    v_lshl_add_u32 v79, v79, 4, s46
    ds_write_b128 v79, v[92:95] offset:4096
    v_lshlrev_b32 v75, 2, v76
    v_sub_u32 v79, v75, v77
    s_add_u32 s46, s44, 2388
    v_add_u32 v0, s46, v79
    v_mul_u32_u24 v79, 288, v76
    v_add3_u32 v80, v79, v77, s44
    s_mov_b32 s46, 0xcbaaa988
    s_mov_b32 s47, 0xa9875421
    v_bfe_u32 v79, s46, v75, 4
    v_min_u32 v79, v79, v76
    v_mul_u32_u24 v79, 288, v79
    v_add3_u32 v81, v79, v77, s44
    v_bfe_u32 v79, s47, v75, 4
    v_and_b32 v78, 8, v76
    v_lshl_add_u32 v79, v78, 1, v79
    v_lshrrev_b32 v78, 1, v77
    v_lshl_add_u32 v79, v79, 6, v78
    v_add_u32 v83, s44, v79
    v_and_b32 v78, 8, v78
    v_lshl_add_u32 v78, v76, 4, v78
    v_and_b32 v79, 32, v11
    v_lshl_add_u32 v78, v79, 4, v78
    v_add_u32 v82, s44, v78
    s_lshr_b32 s46, s4, 1
    s_add_u32 s46, s46, s43
    s_lshl_b32 s46, s46, 2
    s_and_b32 s47, s4, 1
    s_add_u32 s46, s46, s47
    s_add_u32 s46, s46, 2
    s_lshl_b32 s46, s46, 10
    v_lshl_add_u32 v78, v11, 4, s46
    global_load_dword v10, v78, s[34:35]
    global_load_dword v10, v21, s[28:29]
    global_load_dword v10, v21, s[30:31]
    s_waitcnt vmcnt(12)
    v_lshlrev_b32 v118, 16, v118
    v_mul_f32 v118, 0x3fb8aa3b, v118
    v_exp_f32 v118, v118
    s_mov_b32 s52, 0
    s_mov_b32 vcc_lo, 1
    v_cvt_pk_bf16_f32 v74, 0, v118
    v_mul_f32 v72, 0x3fb8aa3b, v74
    v_mul_f32 v73, 0.15915494, v74
    s_waitcnt vmcnt(11)
    v_and_b32 v128, 0xffff0000, v112
    s_waitcnt vmcnt(10)
    v_and_b32 v129, 0xffff0000, v113
    s_waitcnt vmcnt(9)
    v_and_b32 v130, 0xffff0000, v114
    s_waitcnt vmcnt(8)
    v_and_b32 v131, 0xffff0000, v115
    s_waitcnt vmcnt(7)
    v_and_b32 v132, 0xffff0000, v116
    s_waitcnt vmcnt(6)
    v_and_b32 v133, 0xffff0000, v117
    v_mul_f32 v128, v128, v72
    v_mul_f32 v129, v129, v73
    v_mul_f32 v134, 0x43800000, v128
    v_mul_f32 v135, 0x43800000, v129
    v_fract_f32 v129, v129
    v_exp_f32 v128, v128
    v_fract_f32 v135, v135
    v_cos_f32 v138, v129
    v_sin_f32 v139, v129
    v_exp_f32 v134, v134
    v_mul_f32 v130, v130, v74
    v_mul_f32 v131, v131, v74
    v_cos_f32 v156, v135
    v_sin_f32 v157, v135
    v_mul_f32 v138, v138, v128
    v_mul_f32 v139, v139, v128
    v_mul_f32 v156, v156, v134
    v_mul_f32 v157, v157, v134
    s_waitcnt vmcnt(5)
    v_lshlrev_b32 v119, 16, v119
    v_cndmask_b32 v119, 0, v119, vcc
    s_setprio 1
    s_waitcnt lgkmcnt(0)
L_kgen:
    v_pk_mul_f32 v[140:141], v[138:139], v[138:139] op_sel_hi:[0,1]
    v_pk_mul_f32 v[184:185], v[132:133], v[130:131] op_sel_hi:[0,1] neg_hi:[0,1]
    v_pk_fma_f32 v[140:141], v[138:139], v[138:139], v[140:141] op_sel:[1,1,0] op_sel_hi:[1,0,1] neg_lo:[1,0,0]
    v_pk_fma_f32 v[184:185], v[132:133], v[130:131], v[184:185] op_sel:[1,1,0] op_sel_hi:[1,0,1] neg_lo:[1,0,0] neg_hi:[1,0,0]
    v_pk_mul_f32 v[144:145], v[140:141], v[140:141] op_sel_hi:[0,1]
    v_pk_fma_f32 v[144:145], v[140:141], v[140:141], v[144:145] op_sel:[1,1,0] op_sel_hi:[1,0,1] neg_lo:[1,0,0]
    v_pk_mul_f32 v[158:159], v[156:157], v[156:157] op_sel_hi:[0,1]
    v_pk_mul_f32 v[152:153], v[144:145], v[144:145] op_sel_hi:[0,1]
    v_pk_fma_f32 v[158:159], v[156:157], v[156:157], v[158:159] op_sel:[1,1,0] op_sel_hi:[1,0,1] neg_lo:[1,0,0]
    v_pk_fma_f32 v[152:153], v[144:145], v[144:145], v[152:153] op_sel:[1,1,0] op_sel_hi:[1,0,1] neg_lo:[1,0,0]
    v_cvt_pk_bf16_f32 v64, v184, v185
    v_pk_mul_f32 v[186:187], v[184:185], v[152:153] op_sel_hi:[0,1] neg_hi:[0,1]
    v_cvt_pk_bf16_f32 v65, v138, v139
    v_pk_fma_f32 v[186:187], v[184:185], v[152:153], v[186:187] op_sel:[1,1,0] op_sel_hi:[1,0,1]
    v_cvt_pk_bf16_f32 v66, v186, v187
    v_pk_mul_f32 v[188:189], v[186:187], v[152:153] op_sel_hi:[0,1] neg_hi:[0,1]
    v_cvt_pk_bf16_f32 v67, v140, v141
    v_pk_fma_f32 v[188:189], v[186:187], v[152:153], v[188:189] op_sel:[1,1,0] op_sel_hi:[1,0,1]
    ds_write_addtid_b32 v64 offset:6048
    ds_write_addtid_b32 v65 offset:2592
    ds_write_addtid_b32 v66 offset:6336
    ds_write_addtid_b32 v67 offset:2880
    v_cvt_pk_bf16_f32 v68, v188, v189
    v_pk_mul_f32 v[190:191], v[188:189], v[152:153] op_sel_hi:[0,1] neg_hi:[0,1]
    v_cvt_pk_bf16_f32 v69, v144, v145
    v_pk_fma_f32 v[190:191], v[188:189], v[152:153], v[190:191] op_sel:[1,1,0] op_sel_hi:[1,0,1]
    v_cvt_pk_bf16_f32 v70, v190, v191
    v_pk_mul_f32 v[184:185], v[190:191], v[152:153] op_sel_hi:[0,1] neg_hi:[0,1]
    v_cvt_pk_bf16_f32 v71, v156, v157
    v_pk_fma_f32 v[184:185], v[190:191], v[152:153], v[184:185] op_sel:[1,1,0] op_sel_hi:[1,0,1]
    ds_write_addtid_b32 v68 offset:6624
    ds_write_addtid_b32 v69 offset:3456
    ds_write_addtid_b32 v70 offset:6912
    ds_write_addtid_b32 v71 offset:4608
    v_pk_mul_f32 v[142:143], v[140:141], v[138:139] op_sel_hi:[0,1]
    v_cvt_pk_bf16_f32 v52, v184, v185
    v_pk_fma_f32 v[142:143], v[140:141], v[138:139], v[142:143] op_sel:[1,1,0] op_sel_hi:[1,0,1] neg_lo:[1,0,0]
    v_pk_mul_f32 v[186:187], v[184:185], v[152:153] op_sel_hi:[0,1] neg_hi:[0,1]
    v_cvt_pk_bf16_f32 v53, v142, v143
    v_pk_fma_f32 v[186:187], v[184:185], v[152:153], v[186:187] op_sel:[1,1,0] op_sel_hi:[1,0,1]
    s_cmp_lg_u32 s52, 0
    s_cbranch_scc1 L_kg_b0
    global_load_dword v10, v122, s[8:9]
    global_load_dword v10, v123, s[8:9]
    s_branch L_kg_j0
L_kg_b0:
    global_load_dword v12, v6, s[8:9] offset:-4096
    global_load_dword v13, v6, s[8:9] offset:-2048
    global_load_dword v14, v6, s[8:9] offset:0
    global_load_dword v15, v6, s[8:9] offset:2048
L_kg_j0:
    v_pk_mul_f32 v[188:189], v[186:187], v[152:153] op_sel_hi:[0,1] neg_hi:[0,1]
    v_cvt_pk_bf16_f32 v54, v186, v187
    v_pk_fma_f32 v[188:189], v[186:187], v[152:153], v[188:189] op_sel:[1,1,0] op_sel_hi:[1,0,1]
    v_pk_mul_f32 v[146:147], v[144:145], v[138:139] op_sel_hi:[0,1]
    v_cvt_pk_bf16_f32 v55, v188, v189
    v_pk_fma_f32 v[146:147], v[144:145], v[138:139], v[146:147] op_sel:[1,1,0] op_sel_hi:[1,0,1] neg_lo:[1,0,0]
    ds_write_addtid_b32 v52 offset:7200
    ds_write_addtid_b32 v53 offset:3168
    ds_write_addtid_b32 v54 offset:7488
    ds_write_addtid_b32 v55 offset:7776
    v_pk_mul_f32 v[190:191], v[188:189], v[152:153] op_sel_hi:[0,1] neg_hi:[0,1]
    v_cvt_pk_bf16_f32 v56, v146, v147
    v_pk_fma_f32 v[190:191], v[188:189], v[152:153], v[190:191] op_sel:[1,1,0] op_sel_hi:[1,0,1]
    v_pk_mul_f32 v[148:149], v[144:145], v[140:141] op_sel_hi:[0,1]
    v_cvt_pk_bf16_f32 v57, v190, v191
    v_pk_fma_f32 v[148:149], v[144:145], v[140:141], v[148:149] op_sel:[1,1,0] op_sel_hi:[1,0,1] neg_lo:[1,0,0]
    v_pk_mul_f32 v[184:185], v[190:191], v[152:153] op_sel_hi:[0,1] neg_hi:[0,1]
    v_cvt_pk_bf16_f32 v58, v148, v149
    v_pk_fma_f32 v[184:185], v[190:191], v[152:153], v[184:185] op_sel:[1,1,0] op_sel_hi:[1,0,1]
    v_pk_mul_f32 v[150:151], v[144:145], v[142:143] op_sel_hi:[0,1]
    v_cvt_pk_bf16_f32 v59, v184, v185
    v_pk_fma_f32 v[150:151], v[144:145], v[142:143], v[150:151] op_sel:[1,1,0] op_sel_hi:[1,0,1] neg_lo:[1,0,0]
    ds_write_addtid_b32 v56 offset:3744
    ds_write_addtid_b32 v57 offset:8064
    ds_write_addtid_b32 v58 offset:4032
    ds_write_addtid_b32 v59 offset:8352
    v_pk_mul_f32 v[186:187], v[184:185], v[152:153] op_sel_hi:[0,1] neg_hi:[0,1]
    v_cvt_pk_bf16_f32 v64, v150, v151
    v_pk_fma_f32 v[186:187], v[184:185], v[152:153], v[186:187] op_sel:[1,1,0] op_sel_hi:[1,0,1]
    v_pk_mul_f32 v[160:161], v[156:157], v[140:141] op_sel_hi:[0,1]
    v_cvt_pk_bf16_f32 v65, v186, v187
    v_pk_fma_f32 v[160:161], v[156:157], v[140:141], v[160:161] op_sel:[1,1,0] op_sel_hi:[1,0,1] neg_lo:[1,0,0]
    v_pk_mul_f32 v[188:189], v[186:187], v[152:153] op_sel_hi:[0,1] neg_hi:[0,1]
    v_cvt_pk_bf16_f32 v66, v160, v161
    v_pk_fma_f32 v[188:189], v[186:187], v[152:153], v[188:189] op_sel:[1,1,0] op_sel_hi:[1,0,1]
    v_pk_mul_f32 v[162:163], v[156:157], v[144:145] op_sel_hi:[0,1]
    v_cvt_pk_bf16_f32 v67, v188, v189
    v_pk_fma_f32 v[162:163], v[156:157], v[144:145], v[162:163] op_sel:[1,1,0] op_sel_hi:[1,0,1] neg_lo:[1,0,0]
    ds_write_addtid_b32 v64 offset:4320
    ds_write_addtid_b32 v65 offset:8640
    ds_write_addtid_b32 v66 offset:4896
    ds_write_addtid_b32 v67 offset:8928
    v_pk_mul_f32 v[190:191], v[188:189], v[152:153] op_sel_hi:[0,1] neg_hi:[0,1]
    v_cvt_pk_bf16_f32 v68, v162, v163
    v_pk_fma_f32 v[190:191], v[188:189], v[152:153], v[190:191] op_sel:[1,1,0] op_sel_hi:[1,0,1]
    v_pk_mul_f32 v[184:185], v[190:191], v[152:153] op_sel_hi:[0,1] neg_hi:[0,1]
    v_cvt_pk_bf16_f32 v69, v190, v191
    v_pk_fma_f32 v[184:185], v[190:191], v[152:153], v[184:185] op_sel:[1,1,0] op_sel_hi:[1,0,1]
    v_pk_mul_f32 v[164:165], v[156:157], v[148:149] op_sel_hi:[0,1]
    v_cvt_pk_bf16_f32 v70, v184, v185
    v_pk_fma_f32 v[164:165], v[156:157], v[148:149], v[164:165] op_sel:[1,1,0] op_sel_hi:[1,0,1] neg_lo:[1,0,0]
    v_pk_mul_f32 v[186:187], v[184:185], v[152:153] op_sel_hi:[0,1] neg_hi:[0,1]
    v_cvt_pk_bf16_f32 v71, v164, v165
    v_pk_fma_f32 v[186:187], v[184:185], v[152:153], v[186:187] op_sel:[1,1,0] op_sel_hi:[1,0,1]
    ds_write_addtid_b32 v68 offset:5184
    ds_write_addtid_b32 v69 offset:9216
    ds_write_addtid_b32 v70 offset:9504
    ds_write_addtid_b32 v71 offset:5472
    v_pk_mul_f32 v[166:167], v[156:157], v[152:153] op_sel_hi:[0,1]
    v_cvt_pk_bf16_f32 v52, v186, v187
    v_pk_fma_f32 v[166:167], v[156:157], v[152:153], v[166:167] op_sel:[1,1,0] op_sel_hi:[1,0,1] neg_lo:[1,0,0]
    v_pk_mul_f32 v[188:189], v[186:187], v[152:153] op_sel_hi:[0,1] neg_hi:[0,1]
    v_cvt_pk_bf16_f32 v53, v166, v167
    v_pk_fma_f32 v[188:189], v[186:187], v[152:153], v[188:189] op_sel:[1,1,0] op_sel_hi:[1,0,1]
    v_pk_mul_f32 v[168:169], v[158:159], v[144:145] op_sel_hi:[0,1]
    v_cvt_pk_bf16_f32 v54, v188, v189
    v_pk_fma_f32 v[168:169], v[158:159], v[144:145], v[168:169] op_sel:[1,1,0] op_sel_hi:[1,0,1] neg_lo:[1,0,0]
    v_pk_mul_f32 v[190:191], v[188:189], v[152:153] op_sel_hi:[0,1] neg_hi:[0,1]
    v_cvt_pk_bf16_f32 v55, v168, v169
    v_pk_fma_f32 v[190:191], v[188:189], v[152:153], v[190:191] op_sel:[1,1,0] op_sel_hi:[1,0,1]
    ds_write_addtid_b32 v52 offset:9792
    ds_write_addtid_b32 v53 offset:5760
    ds_write_addtid_b32 v54 offset:10080
    ds_write_addtid_b32 v55 offset:0
    ds_read_b128 v[192:195], v81 offset:2304
    ds_read_b128 v[208:211], v81 offset:2368
    ds_read_b128 v[224:227], v81 offset:2432
    ds_read_b128 v[240:243], v81 offset:2496
    v_pk_mul_f32 v[172:173], v[158:159], v[152:153] op_sel_hi:[0,1]
    v_cvt_pk_bf16_f32 v56, v190, v191
    v_pk_fma_f32 v[172:173], v[158:159], v[152:153], v[172:173] op_sel:[1,1,0] op_sel_hi:[1,0,1] neg_lo:[1,0,0]
    v_pk_mul_f32 v[184:185], v[190:191], v[152:153] op_sel_hi:[0,1] neg_hi:[0,1]
    v_cvt_pk_bf16_f32 v57, v172, v173
    v_pk_fma_f32 v[184:185], v[190:191], v[152:153], v[184:185] op_sel:[1,1,0] op_sel_hi:[1,0,1]
    v_pk_mul_f32 v[170:171], v[168:169], v[156:157] op_sel_hi:[0,1]
    v_cvt_pk_bf16_f32 v58, v184, v185
    v_pk_fma_f32 v[170:171], v[168:169], v[156:157], v[170:171] op_sel:[1,1,0] op_sel_hi:[1,0,1] neg_lo:[1,0,0]
    v_pk_mul_f32 v[186:187], v[184:185], v[152:153] op_sel_hi:[0,1] neg_hi:[0,1]
    v_cvt_pk_bf16_f32 v59, v170, v171
    v_pk_fma_f32 v[186:187], v[184:185], v[152:153], v[186:187] op_sel:[1,1,0] op_sel_hi:[1,0,1]
    s_cmp_lg_u32 s52, 0
    s_cbranch_scc1 L_kg_b1
    global_load_dword v10, v22, s[28:29]
    global_load_dword v10, v22, s[30:31]
    s_branch L_kg_j1
L_kg_b1:
    v_add_u32 v6, 0x00100000, v6
    global_load_dword v16, v6, s[8:9] offset:-4096
    global_load_dword v17, v6, s[8:9] offset:-2048
    global_load_dword v18, v6, s[8:9] offset:0
    global_load_dword v19, v6, s[8:9] offset:2048
L_kg_j1:
    ds_write_addtid_b32 v56 offset:10368
    ds_write_addtid_b32 v57 offset:576
    ds_write_addtid_b32 v58 offset:10656
    ds_write_addtid_b32 v59 offset:288
    ds_read_b128 v[196:199], v80 offset:6048
    ds_read_b128 v[212:215], v80 offset:6112
    ds_read_b128 v[228:231], v80 offset:6176
    ds_read_b128 v[244:247], v80 offset:6240
    v_pk_mul_f32 v[188:189], v[186:187], v[152:153] op_sel_hi:[0,1] neg_hi:[0,1]
    v_cvt_pk_bf16_f32 v64, v186, v187
    v_pk_fma_f32 v[188:189], v[186:187], v[152:153], v[188:189] op_sel:[1,1,0] op_sel_hi:[1,0,1]
    v_pk_mul_f32 v[174:175], v[172:173], v[156:157] op_sel_hi:[0,1]
    v_cvt_pk_bf16_f32 v65, v188, v189
    v_pk_fma_f32 v[174:175], v[172:173], v[156:157], v[174:175] op_sel:[1,1,0] op_sel_hi:[1,0,1] neg_lo:[1,0,0]
    v_pk_mul_f32 v[190:191], v[188:189], v[152:153] op_sel_hi:[0,1] neg_hi:[0,1]
    v_cvt_pk_bf16_f32 v66, v174, v175
    v_pk_fma_f32 v[190:191], v[188:189], v[152:153], v[190:191] op_sel:[1,1,0] op_sel_hi:[1,0,1]
    v_pk_mul_f32 v[176:177], v[168:169], v[168:169] op_sel_hi:[0,1]
    v_cvt_pk_bf16_f32 v67, v190, v191
    v_pk_fma_f32 v[176:177], v[168:169], v[168:169], v[176:177] op_sel:[1,1,0] op_sel_hi:[1,0,1] neg_lo:[1,0,0]
    ds_write_addtid_b32 v64 offset:10944
    ds_write_addtid_b32 v65 offset:11232
    ds_write_addtid_b32 v66 offset:864
    ds_write_addtid_b32 v67 offset:11520
    v_pk_mul_f32 v[184:185], v[190:191], v[152:153] op_sel_hi:[0,1] neg_hi:[0,1]
    v_cvt_pk_bf16_f32 v68, v176, v177
    v_pk_fma_f32 v[184:185], v[190:191], v[152:153], v[184:185] op_sel:[1,1,0] op_sel_hi:[1,0,1]
    v_pk_mul_f32 v[178:179], v[176:177], v[156:157] op_sel_hi:[0,1]
    v_cvt_pk_bf16_f32 v69, v184, v185
    v_pk_fma_f32 v[178:179], v[176:177], v[156:157], v[178:179] op_sel:[1,1,0] op_sel_hi:[1,0,1] neg_lo:[1,0,0]
    v_pk_mul_f32 v[186:187], v[184:185], v[152:153] op_sel_hi:[0,1] neg_hi:[0,1]
    v_cvt_pk_bf16_f32 v70, v178, v179
    v_pk_fma_f32 v[186:187], v[184:185], v[152:153], v[186:187] op_sel:[1,1,0] op_sel_hi:[1,0,1]
    v_pk_mul_f32 v[180:181], v[176:177], v[158:159] op_sel_hi:[0,1]
    v_cvt_pk_bf16_f32 v71, v186, v187
    v_pk_fma_f32 v[180:181], v[176:177], v[158:159], v[180:181] op_sel:[1,1,0] op_sel_hi:[1,0,1] neg_lo:[1,0,0]
    ds_write_addtid_b32 v68 offset:1152
    ds_write_addtid_b32 v69 offset:11808
    ds_write_addtid_b32 v70 offset:1440
    ds_write_addtid_b32 v71 offset:12096
    v_pk_mul_f32 v[188:189], v[186:187], v[152:153] op_sel_hi:[0,1] neg_hi:[0,1]
    v_cvt_pk_bf16_f32 v52, v180, v181
    v_pk_fma_f32 v[188:189], v[186:187], v[152:153], v[188:189] op_sel:[1,1,0] op_sel_hi:[1,0,1]
    v_pk_mul_f32 v[182:183], v[178:179], v[158:159] op_sel_hi:[0,1]
    v_cvt_pk_bf16_f32 v53, v188, v189
    v_pk_fma_f32 v[182:183], v[178:179], v[158:159], v[182:183] op_sel:[1,1,0] op_sel_hi:[1,0,1] neg_lo:[1,0,0]
    v_pk_mul_f32 v[190:191], v[188:189], v[152:153] op_sel_hi:[0,1] neg_hi:[0,1]
    v_cvt_pk_bf16_f32 v54, v182, v183
    v_pk_fma_f32 v[190:191], v[188:189], v[152:153], v[190:191] op_sel:[1,1,0] op_sel_hi:[1,0,1]
    v_pk_mul_f32 v[184:185], v[190:191], v[152:153] op_sel_hi:[0,1] neg_hi:[0,1]
    v_cvt_pk_bf16_f32 v55, v190, v191
    v_pk_fma_f32 v[184:185], v[190:191], v[152:153], v[184:185] op_sel:[1,1,0] op_sel_hi:[1,0,1]
    ds_write_addtid_b32 v52 offset:1728
    ds_write_addtid_b32 v53 offset:12384
    ds_write_addtid_b32 v54 offset:2016
    ds_write_addtid_b32 v55 offset:12672
    ds_read_b128 v[204:207], v80 offset:0
    ds_read_b128 v[220:223], v80 offset:64
    ds_read_b128 v[236:239], v80 offset:128
    ds_read_b128 v[252:255], v80 offset:192
    v_pk_mul_f32 v[186:187], v[184:185], v[152:153] op_sel_hi:[0,1] neg_hi:[0,1]
    v_cvt_pk_bf16_f32 v56, v184, v185
    v_pk_fma_f32 v[186:187], v[184:185], v[152:153], v[186:187] op_sel:[1,1,0] op_sel_hi:[1,0,1]
    v_pk_mul_f32 v[188:189], v[186:187], v[152:153] op_sel_hi:[0,1] neg_hi:[0,1]
    v_cvt_pk_bf16_f32 v57, v186, v187
    v_pk_fma_f32 v[188:189], v[186:187], v[152:153], v[188:189] op_sel:[1,1,0] op_sel_hi:[1,0,1]
    v_pk_mul_f32 v[190:191], v[188:189], v[152:153] op_sel_hi:[0,1] neg_hi:[0,1]
    v_cvt_pk_bf16_f32 v58, v188, v189
    v_pk_fma_f32 v[190:191], v[188:189], v[152:153], v[190:191] op_sel:[1,1,0] op_sel_hi:[1,0,1]
    v_pk_mul_f32 v[184:185], v[190:191], v[152:153] op_sel_hi:[0,1] neg_hi:[0,1]
    v_cvt_pk_bf16_f32 v59, v190, v191
    v_pk_fma_f32 v[184:185], v[190:191], v[152:153], v[184:185] op_sel:[1,1,0] op_sel_hi:[1,0,1]
    ds_write_addtid_b32 v56 offset:12960
    ds_write_addtid_b32 v57 offset:13248
    ds_write_addtid_b32 v58 offset:13536
    ds_write_addtid_b32 v59 offset:13824
    v_pk_mul_f32 v[186:187], v[184:185], v[152:153] op_sel_hi:[0,1] neg_hi:[0,1]
    v_cvt_pk_bf16_f32 v64, v184, v185
    v_pk_fma_f32 v[186:187], v[184:185], v[152:153], v[186:187] op_sel:[1,1,0] op_sel_hi:[1,0,1]
    v_pk_mul_f32 v[188:189], v[186:187], v[152:153] op_sel_hi:[0,1] neg_hi:[0,1]
    v_cvt_pk_bf16_f32 v65, v186, v187
    v_pk_fma_f32 v[188:189], v[186:187], v[152:153], v[188:189] op_sel:[1,1,0] op_sel_hi:[1,0,1]
    v_pk_mul_f32 v[190:191], v[188:189], v[152:153] op_sel_hi:[0,1] neg_hi:[0,1]
    v_cvt_pk_bf16_f32 v66, v188, v189
    v_pk_fma_f32 v[190:191], v[188:189], v[152:153], v[190:191] op_sel:[1,1,0] op_sel_hi:[1,0,1]
    v_cvt_pk_bf16_f32 v67, v190, v191
    ds_write_addtid_b32 v64 offset:14112
    ds_write_addtid_b32 v65 offset:14400
    ds_write_addtid_b32 v66 offset:14688
    ds_write_addtid_b32 v67 offset:14976
    ds_read_b128 v[200:203], v80 offset:10656
    ds_read_b128 v[216:219], v80 offset:10720
    ds_read_b128 v[232:235], v80 offset:10784
    ds_read_b128 v[248:251], v80 offset:10848
    s_cmp_lg_u32 s52, 0
    s_cbranch_scc1 L_kg_end
    s_waitcnt lgkmcnt(14)
    v_mfma_f32_16x16x32_bf16 v[96:99], v[192:195], v[196:199], 0
    v_lshlrev_b32 v128, 16, v112
    v_lshlrev_b32 v129, 16, v113
    v_mfma_f32_16x16x32_bf16 v[104:107], v[196:199], v[204:207], 0
    v_lshlrev_b32 v130, 16, v114
    v_lshlrev_b32 v131, 16, v115
    v_mfma_f32_16x16x32_bf16 v[96:99], v[208:211], v[212:215], v[96:99]
    v_lshlrev_b32 v132, 16, v116
    v_lshlrev_b32 v133, 16, v117
    v_mfma_f32_16x16x32_bf16 v[104:107], v[212:215], v[220:223], v[104:107]
    v_mul_f32 v128, v128, v72
    v_mul_f32 v129, v129, v73
    v_mfma_f32_16x16x32_bf16 v[96:99], v[224:227], v[228:231], v[96:99]
    v_mul_f32 v134, 0x43800000, v128
    v_mul_f32 v135, 0x43800000, v129
    s_waitcnt lgkmcnt(13)
    v_mfma_f32_16x16x32_bf16 v[104:107], v[228:231], v[236:239], v[104:107]
    v_fract_f32 v129, v129
    v_exp_f32 v128, v128
    v_mfma_f32_16x16x32_bf16 v[96:99], v[240:243], v[244:247], v[96:99]
    v_fract_f32 v135, v135
    v_cos_f32 v138, v129
    s_waitcnt lgkmcnt(12)
    v_mfma_f32_16x16x32_bf16 v[104:107], v[244:247], v[252:255], v[104:107]
    v_sin_f32 v139, v129
    s_waitcnt lgkmcnt(3)
    v_mfma_f32_16x16x32_bf16 v[100:103], v[192:195], v[200:203], 0
    v_exp_f32 v134, v134
    v_mfma_f32_16x16x32_bf16 v[108:111], v[200:203], v[204:207], 0
    v_mul_f32 v130, v130, v74
    v_mul_f32 v131, v131, v74
    s_waitcnt lgkmcnt(2)
    v_mfma_f32_16x16x32_bf16 v[100:103], v[208:211], v[216:219], v[100:103]
    v_cos_f32 v156, v135
    v_mfma_f32_16x16x32_bf16 v[108:111], v[216:219], v[220:223], v[108:111]
    v_sin_f32 v157, v135
    s_waitcnt lgkmcnt(1)
    v_mfma_f32_16x16x32_bf16 v[100:103], v[224:227], v[232:235], v[100:103]
    v_mul_f32 v138, v138, v128
    v_mul_f32 v139, v139, v128
    v_mfma_f32_16x16x32_bf16 v[108:111], v[232:235], v[236:239], v[108:111]
    v_mul_f32 v156, v156, v134
    v_mul_f32 v157, v157, v134
    s_waitcnt lgkmcnt(0)
    v_mfma_f32_16x16x32_bf16 v[100:103], v[240:243], v[248:251], v[100:103]
    v_mfma_f32_16x16x32_bf16 v[108:111], v[248:251], v[252:255], v[108:111]
    s_cmp_lg_u32 s45, 0
    s_cbranch_scc1 L_kg_np
    s_setprio 0
L_kg_np:
    s_mov_b32 s52, 1
    s_branch L_kgen
L_kg_end:
    s_waitcnt lgkmcnt(14)
    v_mfma_f32_16x16x32_bf16 v[96:99], v[192:195], v[196:199], v[96:99]
    global_load_dword v10, v23, s[28:29]
    global_load_dword v10, v23, s[30:31]
    global_load_dword v10, v20, s[26:27]
    global_load_dword v10, v124, s[8:9]
    v_mfma_f32_16x16x32_bf16 v[104:107], v[196:199], v[204:207], v[104:107]
    v_add_u32 v3, 0xfffffc00, v3
    s_waitcnt vmcnt(8)
    v_perm_b32 v24, v14, v15, s48
    v_mfma_f32_16x16x32_bf16 v[96:99], v[208:211], v[212:215], v[96:99]
    v_perm_b32 v25, v12, v13, s48
    ds_write_b64 v3, v[24:25] offset:1024
    v_perm_b32 v26, v14, v15, s49
    v_mfma_f32_16x16x32_bf16 v[104:107], v[212:215], v[220:223], v[104:107]
    v_perm_b32 v27, v12, v13, s49
    ds_write_b64 v3, v[26:27] offset:5648
    ds_write_addtid_b32 v92 offset:0
    v_mfma_f32_16x16x32_bf16 v[96:99], v[224:227], v[228:231], v[96:99]
    ds_write_addtid_b32 v92 offset:1024
    ds_write_addtid_b32 v92 offset:2256
    ds_write_addtid_b32 v92 offset:2528
    s_waitcnt lgkmcnt(14)
    v_mfma_f32_16x16x32_bf16 v[104:107], v[228:231], v[236:239], v[104:107]
    v_mfma_f32_16x16x32_bf16 v[96:99], v[240:243], v[244:247], v[96:99]
    v_mfma_f32_16x16x32_bf16 v[104:107], v[244:247], v[252:255], v[104:107]
    s_waitcnt lgkmcnt(9)
    v_mfma_f32_16x16x32_bf16 v[100:103], v[192:195], v[200:203], v[100:103]
    v_mfma_f32_16x16x32_bf16 v[108:111], v[200:203], v[204:207], v[108:111]
    s_waitcnt lgkmcnt(8)
    v_mfma_f32_16x16x32_bf16 v[100:103], v[208:211], v[216:219], v[100:103]
    v_mfma_f32_16x16x32_bf16 v[108:111], v[216:219], v[220:223], v[108:111]
    s_waitcnt lgkmcnt(7)
    v_mfma_f32_16x16x32_bf16 v[100:103], v[224:227], v[232:235], v[100:103]
    v_mfma_f32_16x16x32_bf16 v[108:111], v[232:235], v[236:239], v[108:111]
    s_waitcnt lgkmcnt(6)
    v_mfma_f32_16x16x32_bf16 v[100:103], v[240:243], v[248:251], v[100:103]
    v_mfma_f32_16x16x32_bf16 v[108:111], v[248:251], v[252:255], v[108:111]
    s_setprio 0
    s_nop 4
    v_add_f32 v96, v96, v119
    v_cvt_pk_bf16_f32 v112, v96, v97
    v_cvt_pk_bf16_f32 v113, v98, v99
    v_cvt_pk_bf16_f32 v114, v100, v101
    v_cvt_pk_bf16_f32 v115, v102, v103
    v_cvt_pk_bf16_f32 v116, v104, v105
    v_cvt_pk_bf16_f32 v117, v106, v107
    v_cvt_pk_bf16_f32 v118, v108, v109
    v_cvt_pk_bf16_f32 v119, v110, v111
    v_cvt_pk_bf16_f32 v120, v97, v98
    v_cvt_pk_bf16_f32 v121, v101, v102
    ds_write_b64 v82, v[112:113] offset:32
    ds_write_b16 v82, v112 offset:1246
    ds_write_b32 v82, v120 offset:1248
    ds_write_b16_d16_hi v82, v113 offset:1252
    ds_write_b64 v82, v[114:115] offset:288
    ds_write_b16 v82, v114 offset:1502
    ds_write_b32 v82, v121 offset:1504
    ds_write_b16_d16_hi v82, v115 offset:1508
    ds_write_b64 v83, v[116:117] offset:2336
    ds_write_b64 v83, v[118:119] offset:2368
    v_readlane_b32 s50, v115, 63
    v_readlane_b32 s51, v119, 51
    ds_read2_b32 v[232:233], v8 offset0:0 offset1:1
    ds_read2_b32 v[234:235], v8 offset0:2 offset1:3
    ds_read2_b32 v[128:129], v7 offset0:0 offset1:1
    ds_read2_b32 v[130:131], v7 offset0:2 offset1:3
    ds_read2_b32 v[160:161], v7 offset0:128 offset1:129
    ds_read2_b32 v[162:163], v7 offset0:130 offset1:131
    ds_read2_b32 v[132:133], v7 offset0:16 offset1:17
    ds_read2_b32 v[134:135], v7 offset0:18 offset1:19
    ds_read2_b32 v[164:165], v7 offset0:144 offset1:145
    ds_read2_b32 v[166:167], v7 offset0:146 offset1:147
    s_pack_hh_b32_b16 s50, s50, s50
    s_pack_hh_b32_b16 s51, s51, s51
    v_and_b32 v44, s51, v44
    v_and_b32 v45, s51, v45
    v_and_b32 v46, s51, v46
    v_and_b32 v47, s51, v47
    s_waitcnt lgkmcnt(9)
    v_and_or_b32 v232, v48, s50, v232
    v_and_or_b32 v233, v49, s50, v233
    s_waitcnt lgkmcnt(8)
    v_and_or_b32 v234, v50, s50, v234
    v_and_or_b32 v235, v51, s50, v235
    s_waitcnt vmcnt(4)
    v_perm_b32 v24, v18, v19, s48
    v_perm_b32 v25, v16, v17, s48
    ds_write_b64 v3, v[24:25] offset:0
    v_perm_b32 v26, v18, v19, s49
    v_perm_b32 v27, v16, v17, s49
    ds_write_b64 v3, v[26:27] offset:4624
    s_waitcnt lgkmcnt(0)
    s_barrier
    s_cmp_eq_u32 s45, 0
    s_cbranch_scc1 L_A_M0
    v_add_u32 v6, 0x00080000, v6
    global_load_dword v12, v6, s[8:9] offset:-4096
    global_load_dword v13, v6, s[8:9] offset:-2048
    global_load_dword v14, v6, s[8:9] offset:0
    global_load_dword v15, v6, s[8:9] offset:2048
    v_add_u32 v6, 0x00080000, v6
    global_load_dword v16, v6, s[8:9] offset:-4096
    global_load_dword v17, v6, s[8:9] offset:-2048
    global_load_dword v18, v6, s[8:9] offset:0
    global_load_dword v19, v6, s[8:9] offset:2048
    global_load_dword v10, v21, s[26:27]
    global_load_dword v10, v125, s[8:9]
    global_load_dword v10, v22, s[26:27]
    global_load_dword v10, v23, s[26:27]
    v_add_u32 v21, 0xffff8000, v21
    v_add_u32 v22, 0xffff8000, v22
    v_add_u32 v23, 0xffff8000, v23
    v_add_u32 v125, 0xffff8000, v125
    global_load_dword v10, v21, s[26:27]
    global_load_dword v10, v125, s[8:9]
    global_load_dword v10, v22, s[26:27]
    global_load_dword v10, v23, s[26:27]
    v_add_u32 v3, 0xfffffc00, v3
    s_waitcnt vmcnt(12)
    v_perm_b32 v24, v14, v15, s48
    v_perm_b32 v25, v12, v13, s48
    ds_write_b64 v3, v[24:25] offset:512
    v_perm_b32 v26, v14, v15, s49
    v_perm_b32 v27, v12, v13, s49
    ds_write_b64 v3, v[26:27] offset:5136
    s_waitcnt vmcnt(8)
    v_perm_b32 v24, v18, v19, s48
    v_perm_b32 v25, v16, v17, s48
    ds_write_b64 v3, v[24:25] offset:0
    v_perm_b32 v26, v18, v19, s49
    v_perm_b32 v27, v16, v17, s49
    ds_write_b64 v3, v[26:27] offset:4624
    s_waitcnt lgkmcnt(0)
L_A_M0:
    ds_read_b128 v[80:83], v2 offset:3584
    ds_read_b128 v[84:87], v2 offset:3072
    ds_read_b128 v[52:55], v2 offset:3584
    ds_read_b128 v[56:59], v2 offset:3600
    ds_read_b128 v[88:91], v2 offset:3648
    ds_read_b128 v[92:95], v2 offset:3136
    s_waitcnt lgkmcnt(5)
    v_mfma_f32_16x16x32_bf16 v[96:99], v[128:131], v[80:83], 0
    ds_read_b128 v[72:75], v2 offset:3712
    v_mfma_f32_16x16x32_bf16 v[100:103], v[160:163], v[80:83], 0
    ds_read_b128 v[76:79], v2 offset:3200
    s_waitcnt lgkmcnt(6)
    v_mfma_f32_16x16x32_bf16 v[100:103], v[128:131], v[84:87], v[100:103]
    ds_read2_b32 v[136:137], v7 offset0:32 offset1:33
    v_mfma_f32_16x16x32_bf16 v[104:107], v[160:163], v[84:87], 0
    ds_read2_b32 v[138:139], v7 offset0:34 offset1:35
    v_mfma_f32_16x16x32_bf16 v[104:107], v[232:235], v[80:83], v[104:107]
    ds_read2_b32 v[168:169], v7 offset0:160 offset1:161
    v_mfma_f32_16x16x32_bf16 v[108:111], v[232:235], v[84:87], 0
    ds_read2_b32 v[170:171], v7 offset0:162 offset1:163
    v_mfma_f32_16x16x32_bf16 v[112:115], v[44:47], v[80:83], 0
    ds_read2_b32 v[140:141], v7 offset0:48 offset1:49
    v_mfma_f32_16x16x32_bf16 v[116:119], v[44:47], v[84:87], 0
    s_cmp_eq_u32 s45, 0
    s_cbranch_scc1 L_A_nb
    s_barrier
L_A_nb:
    s_setprio 2
    ds_read2_b32 v[142:143], v7 offset0:50 offset1:51
    s_waitcnt lgkmcnt(11)
    v_mfma_f32_16x16x32_bf16 v[236:239], v[52:55], v[32:35], 0
    ds_read2_b32 v[172:173], v7 offset0:176 offset1:177
    s_waitcnt lgkmcnt(11)
    v_mfma_f32_16x16x32_bf16 v[240:243], v[56:59], v[28:31], 0
    ds_read2_b32 v[174:175], v7 offset0:178 offset1:179
    v_mfma_f32_16x16x32_bf16 v[244:247], v[52:55], v[36:39], 0
    ds_read2_b32 v[144:145], v7 offset0:64 offset1:65
    v_mfma_f32_16x16x32_bf16 v[248:251], v[56:59], v[36:39], 0
    ds_read2_b32 v[146:147], v7 offset0:66 offset1:67
    v_mfma_f32_16x16x32_bf16 v[252:255], v[52:55], v[40:43], 0
    ds_read2_b32 v[176:177], v7 offset0:192 offset1:193
    v_mfma_f32_16x16x32_bf16 v[64:67], v[56:59], v[40:43], 0
    ds_read2_b32 v[178:179], v7 offset0:194 offset1:195
    s_waitcnt lgkmcnt(14)
    v_mfma_f32_16x16x32_bf16 v[96:99], v[132:135], v[88:91], v[96:99]
    ds_read_b128 v[52:55], v2 offset:3072
    v_mfma_f32_16x16x32_bf16 v[100:103], v[164:167], v[88:91], v[100:103]
    ds_read_b128 v[56:59], v2 offset:3088
    v_mfma_f32_16x16x32_bf16 v[100:103], v[132:135], v[92:95], v[100:103]
    ds_read_b128 v[80:83], v2 offset:3776
    v_cvt_pk_bf16_f32 v60, v239, v243
    v_cvt_pk_bf16_f32 v61, v238, v242
    v_mfma_f32_16x16x32_bf16 v[104:107], v[164:167], v[92:95], v[104:107]
    ds_read_b128 v[84:87], v2 offset:3264
    v_cvt_pk_bf16_f32 v62, v237, v241
    v_cvt_pk_bf16_f32 v63, v236, v240
    s_waitcnt lgkmcnt(14)
    v_mfma_f32_16x16x32_bf16 v[96:99], v[136:139], v[72:75], v[96:99]
    ds_read_b128 v[88:91], v2 offset:3840
    v_cvt_pk_bf16_f32 v48, v247, v251
    v_cvt_pk_bf16_f32 v49, v246, v250
    s_waitcnt lgkmcnt(13)
    v_mfma_f32_16x16x32_bf16 v[100:103], v[168:171], v[72:75], v[100:103]
    ds_read_b128 v[92:95], v2 offset:3328
    v_cvt_pk_bf16_f32 v50, v245, v249
    v_cvt_pk_bf16_f32 v51, v244, v248
    v_mfma_f32_16x16x32_bf16 v[100:103], v[136:139], v[76:79], v[100:103]
    ds_read2_b32 v[148:149], v7 offset0:80 offset1:81
    v_cvt_pk_bf16_f32 v68, v255, v67
    v_cvt_pk_bf16_f32 v69, v254, v66
    v_mfma_f32_16x16x32_bf16 v[104:107], v[168:171], v[76:79], v[104:107]
    ds_read2_b32 v[150:151], v7 offset0:82 offset1:83
    v_cvt_pk_bf16_f32 v70, v253, v65
    v_cvt_pk_bf16_f32 v71, v252, v64
    s_waitcnt lgkmcnt(7)
    v_mfma_f32_16x16x32_bf16 v[236:239], v[52:55], v[32:35], 0
    ds_read2_b32 v[180:181], v7 offset0:208 offset1:209
    s_waitcnt lgkmcnt(7)
    v_mfma_f32_16x16x32_bf16 v[240:243], v[56:59], v[28:31], 0
    ds_read2_b32 v[182:183], v7 offset0:210 offset1:211
    v_mfma_f32_16x16x32_bf16 v[244:247], v[52:55], v[36:39], 0
    ds_read2_b32 v[152:153], v7 offset0:96 offset1:97
    v_mfma_f32_16x16x32_bf16 v[248:251], v[56:59], v[36:39], 0
    ds_read2_b32 v[154:155], v7 offset0:98 offset1:99
    v_mfma_f32_16x16x32_bf16 v[252:255], v[52:55], v[40:43], 0
    ds_read2_b32 v[184:185], v7 offset0:224 offset1:225
    v_mfma_f32_16x16x32_bf16 v[64:67], v[56:59], v[40:43], 0
    ds_read2_b32 v[186:187], v7 offset0:226 offset1:227
    s_waitcnt lgkmcnt(11)
    v_mfma_f32_16x16x32_bf16 v[96:99], v[140:143], v[80:83], v[96:99]
    ds_read_b128 v[52:55], v2 offset:2560
    v_mfma_f32_16x16x32_bf16 v[100:103], v[172:175], v[80:83], v[100:103]
    ds_read_b128 v[56:59], v2 offset:2576
    s_waitcnt lgkmcnt(12)
    v_mfma_f32_16x16x32_bf16 v[100:103], v[140:143], v[84:87], v[100:103]
    ds_read_b128 v[72:75], v2 offset:3904
    v_cvt_pk_bf16_f32 v24, v239, v243
    v_cvt_pk_bf16_f32 v25, v238, v242
    v_mfma_f32_16x16x32_bf16 v[104:107], v[172:175], v[84:87], v[104:107]
    ds_read_b128 v[76:79], v2 offset:3392
    v_cvt_pk_bf16_f32 v26, v237, v241
    v_cvt_pk_bf16_f32 v27, v236, v240
    s_waitcnt lgkmcnt(13)
    v_mfma_f32_16x16x32_bf16 v[96:99], v[144:147], v[88:91], v[96:99]
    ds_read_b128 v[80:83], v2 offset:3968
    v_cvt_pk_bf16_f32 v12, v247, v251
    v_cvt_pk_bf16_f32 v13, v246, v250
    v_mfma_f32_16x16x32_bf16 v[100:103], v[176:179], v[88:91], v[100:103]
    ds_read_b128 v[84:87], v2 offset:3456
    v_cvt_pk_bf16_f32 v14, v245, v249
    v_cvt_pk_bf16_f32 v15, v244, v248
    s_waitcnt lgkmcnt(14)
    v_mfma_f32_16x16x32_bf16 v[100:103], v[144:147], v[92:95], v[100:103]
    ds_read2_b32 v[156:157], v7 offset0:112 offset1:113
    v_cvt_pk_bf16_f32 v16, v255, v67
    v_cvt_pk_bf16_f32 v17, v254, v66
    v_mfma_f32_16x16x32_bf16 v[104:107], v[176:179], v[92:95], v[104:107]
    ds_read2_b32 v[158:159], v7 offset0:114 offset1:115
    v_cvt_pk_bf16_f32 v18, v253, v65
    v_cvt_pk_bf16_f32 v19, v252, v64
    s_waitcnt lgkmcnt(5)
    v_mfma_f32_16x16x32_bf16 v[96:99], v[148:151], v[72:75], v[96:99]
    ds_read_b128 v[88:91], v2 offset:4032
    v_mfma_f32_16x16x32_bf16 v[100:103], v[180:183], v[72:75], v[100:103]
    ds_read_b128 v[92:95], v2 offset:3520
    s_waitcnt lgkmcnt(6)
    v_mfma_f32_16x16x32_bf16 v[100:103], v[148:151], v[76:79], v[100:103]
    ds_read2_b32 v[188:189], v7 offset0:240 offset1:241
    v_mfma_f32_16x16x32_bf16 v[104:107], v[180:183], v[76:79], v[104:107]
    ds_read2_b32 v[190:191], v7 offset0:242 offset1:243
    s_waitcnt lgkmcnt(7)
    v_mfma_f32_16x16x32_bf16 v[96:99], v[152:155], v[80:83], v[96:99]
    ds_read_b128 v[72:75], v2 offset:2560
    v_mfma_f32_16x16x32_bf16 v[100:103], v[184:187], v[80:83], v[100:103]
    ds_read_b128 v[76:79], v2 offset:2048
    s_waitcnt lgkmcnt(8)
    v_mfma_f32_16x16x32_bf16 v[100:103], v[152:155], v[84:87], v[100:103]
    ds_read2_b32 v[220:221], v0 offset0:48 offset1:49
    v_mfma_f32_16x16x32_bf16 v[104:107], v[184:187], v[84:87], v[104:107]
    ds_read2_b32 v[222:223], v0 offset0:50 offset1:51
    s_waitcnt lgkmcnt(7)
    v_mfma_f32_16x16x32_bf16 v[96:99], v[156:159], v[88:91], v[96:99]
    ds_read_b128 v[80:83], v2 offset:2624
    s_waitcnt lgkmcnt(5)
    v_mfma_f32_16x16x32_bf16 v[100:103], v[188:191], v[88:91], v[100:103]
    ds_read_b128 v[84:87], v2 offset:2112
    v_mfma_f32_16x16x32_bf16 v[100:103], v[156:159], v[92:95], v[100:103]
    ds_read2_b32 v[224:225], v0 offset0:64 offset1:65
    v_mfma_f32_16x16x32_bf16 v[104:107], v[188:191], v[92:95], v[104:107]
    ds_read2_b32 v[226:227], v0 offset0:66 offset1:67
    s_waitcnt lgkmcnt(7)
    v_mfma_f32_16x16x32_bf16 v[104:107], v[128:131], v[72:75], v[104:107]
    ds_read_b128 v[88:91], v2 offset:2688
    v_mfma_f32_16x16x32_bf16 v[108:111], v[160:163], v[72:75], v[108:111]
    ds_read_b128 v[92:95], v2 offset:2176
    s_waitcnt lgkmcnt(8)
    v_mfma_f32_16x16x32_bf16 v[108:111], v[128:131], v[76:79], v[108:111]
    ds_read2_b32 v[228:229], v0 offset0:80 offset1:81
    v_mfma_f32_16x16x32_bf16 v[112:115], v[160:163], v[76:79], v[112:115]
    ds_read2_b32 v[230:231], v0 offset0:82 offset1:83
    v_cvt_pk_bf16_f32 v20, v96, v97
    v_cvt_pk_bf16_f32 v21, v98, v99
    v_mfma_f32_16x16x32_bf16 v[112:115], v[232:235], v[72:75], v[112:115]
    ds_read2_b32 v[208:209], v0 offset0:0 offset1:1
    ds_write_b64 v4, v[20:21] offset:0
    v_cvt_pk_bf16_f32 v22, v100, v101
    v_mfma_f32_16x16x32_bf16 v[116:119], v[232:235], v[76:79], v[116:119]
    ds_read2_b32 v[210:211], v0 offset0:2 offset1:3
    v_cvt_pk_bf16_f32 v23, v102, v103
    ds_write_b64 v4, v[22:23] offset:512
    v_mfma_f32_16x16x32_bf16 v[120:123], v[44:47], v[72:75], 0
    ds_read2_b32 v[212:213], v0 offset0:16 offset1:17
    v_mfma_f32_16x16x32_bf16 v[124:127], v[44:47], v[76:79], 0
    ds_read2_b32 v[214:215], v0 offset0:18 offset1:19
    s_waitcnt lgkmcnt(13)
    v_mfma_f32_16x16x32_bf16 v[104:107], v[132:135], v[80:83], v[104:107]
    ds_read_b128 v[72:75], v2 offset:2752
    v_mfma_f32_16x16x32_bf16 v[108:111], v[164:167], v[80:83], v[108:111]
    ds_read_b128 v[76:79], v2 offset:2240
    s_waitcnt lgkmcnt(14)
    v_mfma_f32_16x16x32_bf16 v[108:111], v[132:135], v[84:87], v[108:111]
    ds_read2_b32 v[216:217], v0 offset0:32 offset1:33
    v_mfma_f32_16x16x32_bf16 v[112:115], v[164:167], v[84:87], v[112:115]
    s_waitcnt lgkmcnt(5)
    s_cmp_eq_u32 s45, 0
    s_cbranch_scc1 L_A_nm0
    s_barrier
L_A_nm0:
    ds_read2_b32 v[218:219], v0 offset0:34 offset1:35
    v_mfma_f32_16x16x32_bf16 v[104:107], v[136:139], v[88:91], v[104:107]
    ds_read_b128 v[80:83], v2 offset:2816
    v_mfma_f32_16x16x32_bf16 v[108:111], v[168:171], v[88:91], v[108:111]
    ds_read_b128 v[84:87], v2 offset:2304
    v_mfma_f32_16x16x32_bf16 v[108:111], v[136:139], v[92:95], v[108:111]
    ds_read2_b32 v[192:193], v0 offset0:96 offset1:97
    v_mfma_f32_16x16x32_bf16 v[112:115], v[168:171], v[92:95], v[112:115]
    ds_read2_b32 v[194:195], v0 offset0:98 offset1:99
    s_waitcnt lgkmcnt(7)
    v_mfma_f32_16x16x32_bf16 v[104:107], v[140:143], v[72:75], v[104:107]
    ds_read_b128 v[88:91], v2 offset:2880
    v_mfma_f32_16x16x32_bf16 v[108:111], v[172:175], v[72:75], v[108:111]
    ds_read_b128 v[92:95], v2 offset:2368
    s_waitcnt lgkmcnt(8)
    v_mfma_f32_16x16x32_bf16 v[108:111], v[140:143], v[76:79], v[108:111]
    ds_read2_b32 v[196:197], v0 offset0:112 offset1:113
    v_mfma_f32_16x16x32_bf16 v[112:115], v[172:175], v[76:79], v[112:115]
    ds_read2_b32 v[198:199], v0 offset0:114 offset1:115
    s_waitcnt lgkmcnt(7)
    v_mfma_f32_16x16x32_bf16 v[104:107], v[144:147], v[80:83], v[104:107]
    ds_read_b128 v[72:75], v2 offset:2944
    v_mfma_f32_16x16x32_bf16 v[108:111], v[176:179], v[80:83], v[108:111]
    ds_read_b128 v[76:79], v2 offset:2432
    s_waitcnt lgkmcnt(8)
    v_mfma_f32_16x16x32_bf16 v[108:111], v[144:147], v[84:87], v[108:111]
    ds_read2_b32 v[200:201], v0 offset0:128 offset1:129
    v_mfma_f32_16x16x32_bf16 v[112:115], v[176:179], v[84:87], v[112:115]
    ds_read2_b32 v[202:203], v0 offset0:130 offset1:131
    v_mfma_f32_16x16x32_bf16 v[104:107], v[48:51], v[220:223], v[104:107]
    ds_read2_b32 v[204:205], v0 offset0:144 offset1:145
    v_mfma_f32_16x16x32_bf16 v[108:111], v[48:51], v[224:227], v[108:111]
    ds_read2_b32 v[206:207], v0 offset0:146 offset1:147
    v_mfma_f32_16x16x32_bf16 v[112:115], v[48:51], v[228:231], v[112:115]
    v_mfma_f32_16x16x32_bf16 v[104:107], v[68:71], v[208:211], v[104:107]
    v_mfma_f32_16x16x32_bf16 v[108:111], v[68:71], v[212:215], v[108:111]
    v_mfma_f32_16x16x32_bf16 v[112:115], v[68:71], v[216:219], v[112:115]
    s_waitcnt lgkmcnt(10)
    v_mfma_f32_16x16x32_bf16 v[112:115], v[60:63], v[192:195], v[112:115]
    s_waitcnt lgkmcnt(6)
    v_mfma_f32_16x16x32_bf16 v[116:119], v[60:63], v[196:199], v[116:119]
    s_waitcnt lgkmcnt(2)
    v_mfma_f32_16x16x32_bf16 v[120:123], v[60:63], v[200:203], v[120:123]
    s_waitcnt lgkmcnt(0)
    v_mfma_f32_16x16x32_bf16 v[124:127], v[60:63], v[204:207], v[124:127]
    v_mfma_f32_16x16x32_bf16 v[236:239], v[52:55], v[32:35], 0
    v_mfma_f32_16x16x32_bf16 v[240:243], v[56:59], v[28:31], 0
    v_mfma_f32_16x16x32_bf16 v[244:247], v[52:55], v[36:39], 0
    v_mfma_f32_16x16x32_bf16 v[248:251], v[56:59], v[36:39], 0
    v_mfma_f32_16x16x32_bf16 v[252:255], v[52:55], v[40:43], 0
    v_mfma_f32_16x16x32_bf16 v[64:67], v[56:59], v[40:43], 0
    v_mfma_f32_16x16x32_bf16 v[108:111], v[12:15], v[220:223], v[108:111]
    ds_read_b128 v[52:55], v2 offset:2048
    v_mfma_f32_16x16x32_bf16 v[112:115], v[12:15], v[224:227], v[112:115]
    ds_read_b128 v[56:59], v2 offset:2064
    v_mfma_f32_16x16x32_bf16 v[116:119], v[12:15], v[228:231], v[116:119]
    v_cvt_pk_bf16_f32 v60, v239, v243
    v_cvt_pk_bf16_f32 v61, v238, v242
    v_mfma_f32_16x16x32_bf16 v[108:111], v[16:19], v[208:211], v[108:111]
    v_cvt_pk_bf16_f32 v62, v237, v241
    v_cvt_pk_bf16_f32 v63, v236, v240
    v_mfma_f32_16x16x32_bf16 v[112:115], v[16:19], v[212:215], v[112:115]
    v_cvt_pk_bf16_f32 v48, v247, v251
    v_cvt_pk_bf16_f32 v49, v246, v250
    v_mfma_f32_16x16x32_bf16 v[116:119], v[16:19], v[216:219], v[116:119]
    v_cvt_pk_bf16_f32 v50, v245, v249
    v_cvt_pk_bf16_f32 v51, v244, v248
    v_mfma_f32_16x16x32_bf16 v[116:119], v[24:27], v[192:195], v[116:119]
    v_cvt_pk_bf16_f32 v68, v255, v67
    v_cvt_pk_bf16_f32 v69, v254, v66
    v_mfma_f32_16x16x32_bf16 v[120:123], v[24:27], v[196:199], v[120:123]
    v_cvt_pk_bf16_f32 v70, v253, v65
    v_cvt_pk_bf16_f32 v71, v252, v64
    v_mfma_f32_16x16x32_bf16 v[124:127], v[24:27], v[200:203], v[124:127]
    v_mfma_f32_16x16x32_bf16 v[104:107], v[148:151], v[88:91], v[104:107]
    ds_read_b128 v[80:83], v2 offset:3008
    v_mfma_f32_16x16x32_bf16 v[108:111], v[180:183], v[88:91], v[108:111]
    ds_read_b128 v[84:87], v2 offset:2496
    v_mfma_f32_16x16x32_bf16 v[108:111], v[148:151], v[92:95], v[108:111]
    v_mfma_f32_16x16x32_bf16 v[112:115], v[180:183], v[92:95], v[112:115]
    s_waitcnt lgkmcnt(3)
    v_mfma_f32_16x16x32_bf16 v[236:239], v[52:55], v[32:35], 0
    s_waitcnt lgkmcnt(2)
    v_mfma_f32_16x16x32_bf16 v[240:243], v[56:59], v[28:31], 0
    v_mfma_f32_16x16x32_bf16 v[244:247], v[52:55], v[36:39], 0
    v_mfma_f32_16x16x32_bf16 v[248:251], v[56:59], v[36:39], 0
    v_mfma_f32_16x16x32_bf16 v[252:255], v[52:55], v[40:43], 0
    v_mfma_f32_16x16x32_bf16 v[64:67], v[56:59], v[40:43], 0
    v_mfma_f32_16x16x32_bf16 v[112:115], v[48:51], v[220:223], v[112:115]
    v_mfma_f32_16x16x32_bf16 v[116:119], v[48:51], v[224:227], v[116:119]
    v_mfma_f32_16x16x32_bf16 v[120:123], v[48:51], v[228:231], v[120:123]
    s_nop 0
    v_cvt_pk_bf16_f32 v24, v239, v243
    v_cvt_pk_bf16_f32 v25, v238, v242
    v_mfma_f32_16x16x32_bf16 v[112:115], v[68:71], v[208:211], v[112:115]
    v_cvt_pk_bf16_f32 v26, v237, v241
    v_cvt_pk_bf16_f32 v27, v236, v240
    v_mfma_f32_16x16x32_bf16 v[116:119], v[68:71], v[212:215], v[116:119]
    v_cvt_pk_bf16_f32 v12, v247, v251
    v_cvt_pk_bf16_f32 v13, v246, v250
    v_mfma_f32_16x16x32_bf16 v[120:123], v[68:71], v[216:219], v[120:123]
    v_cvt_pk_bf16_f32 v14, v245, v249
    v_cvt_pk_bf16_f32 v15, v244, v248
    v_mfma_f32_16x16x32_bf16 v[120:123], v[60:63], v[192:195], v[120:123]
    v_cvt_pk_bf16_f32 v16, v255, v67
    v_cvt_pk_bf16_f32 v17, v254, v66
    v_mfma_f32_16x16x32_bf16 v[124:127], v[60:63], v[196:199], v[124:127]
    v_cvt_pk_bf16_f32 v18, v253, v65
    v_cvt_pk_bf16_f32 v19, v252, v64
    v_mfma_f32_16x16x32_bf16 v[104:107], v[152:155], v[72:75], v[104:107]
    v_mfma_f32_16x16x32_bf16 v[108:111], v[184:187], v[72:75], v[108:111]
    v_mfma_f32_16x16x32_bf16 v[108:111], v[152:155], v[76:79], v[108:111]
    v_mfma_f32_16x16x32_bf16 v[112:115], v[184:187], v[76:79], v[112:115]
    s_waitcnt lgkmcnt(1)
    v_mfma_f32_16x16x32_bf16 v[104:107], v[156:159], v[80:83], v[104:107]
    v_mfma_f32_16x16x32_bf16 v[108:111], v[188:191], v[80:83], v[108:111]
    s_waitcnt lgkmcnt(0)
    v_mfma_f32_16x16x32_bf16 v[108:111], v[156:159], v[84:87], v[108:111]
    v_mfma_f32_16x16x32_bf16 v[112:115], v[188:191], v[84:87], v[112:115]
    v_mfma_f32_16x16x32_bf16 v[116:119], v[12:15], v[220:223], v[116:119]
    v_mfma_f32_16x16x32_bf16 v[120:123], v[12:15], v[224:227], v[120:123]
    v_mfma_f32_16x16x32_bf16 v[124:127], v[12:15], v[228:231], v[124:127]
    v_mfma_f32_16x16x32_bf16 v[116:119], v[16:19], v[208:211], v[116:119]
    v_cvt_pk_bf16_f32 v20, v104, v105
    v_cvt_pk_bf16_f32 v21, v106, v107
    v_mfma_f32_16x16x32_bf16 v[120:123], v[16:19], v[212:215], v[120:123]
    ds_write_b64 v4, v[20:21] offset:1024
    v_cvt_pk_bf16_f32 v22, v108, v109
    v_mfma_f32_16x16x32_bf16 v[124:127], v[16:19], v[216:219], v[124:127]
    v_cvt_pk_bf16_f32 v23, v110, v111
    ds_write_b64 v4, v[22:23] offset:1536
    v_mfma_f32_16x16x32_bf16 v[124:127], v[24:27], v[192:195], v[124:127]
    s_waitcnt lgkmcnt(0)
    s_barrier
    s_setprio 0
    s_cmp_eq_u32 s45, 0
    s_cbranch_scc1 L_A_S1
    ds_read_b64_tr_b16 v[84:85], v5 offset:1024
    ds_read_b64_tr_b16 v[86:87], v5 offset:62720
    v_add_u32 v9, 0x00100000, v9
    s_waitcnt lgkmcnt(0)
    global_store_dwordx4 v9, v[84:87], s[38:39]
    ds_read_b64_tr_b16 v[64:65], v5 offset:1536
    ds_read_b64_tr_b16 v[66:67], v5 offset:63232
    v_add_u32 v9, 0x00100000, v9
    s_waitcnt lgkmcnt(0)
    global_store_dwordx4 v9, v[64:67], s[38:39]
    s_branch L_A_M1
L_A_S1:
    v_add_u32 v6, 0x00200000, v6
    global_load_dword v12, v6, s[8:9] offset:-4096
    global_load_dword v13, v6, s[8:9] offset:-2048
    global_load_dword v14, v6, s[8:9] offset:0
    global_load_dword v15, v6, s[8:9] offset:2048
    v_add_u32 v6, 0x00080000, v6
    global_load_dword v16, v6, s[8:9] offset:-4096
    global_load_dword v17, v6, s[8:9] offset:-2048
    global_load_dword v18, v6, s[8:9] offset:0
    global_load_dword v19, v6, s[8:9] offset:2048
    s_barrier
    ds_read_b64_tr_b16 v[84:85], v5 offset:512
    ds_read_b64_tr_b16 v[86:87], v5 offset:62208
    s_waitcnt lgkmcnt(0)
    global_store_dwordx4 v9, v[84:87], s[38:39]
    ds_read_b64_tr_b16 v[64:65], v5 offset:1024
    ds_read_b64_tr_b16 v[66:67], v5 offset:62720
    v_add_u32 v9, 0x00100000, v9
    s_waitcnt lgkmcnt(0)
    global_store_dwordx4 v9, v[64:67], s[38:39]
    v_add_u32 v3, 0xfffff600, v3
    s_waitcnt vmcnt(6)
    v_perm_b32 v24, v14, v15, s48
    v_perm_b32 v25, v12, v13, s48
    ds_write_b64 v3, v[24:25] offset:512
    v_perm_b32 v26, v14, v15, s49
    v_perm_b32 v27, v12, v13, s49
    ds_write_b64 v3, v[26:27] offset:5136
    s_waitcnt vmcnt(2)
    v_perm_b32 v24, v18, v19, s48
    v_perm_b32 v25, v16, v17, s48
    ds_write_b64 v3, v[24:25] offset:0
    v_perm_b32 v26, v18, v19, s49
    v_perm_b32 v27, v16, v17, s49
    ds_write_b64 v3, v[26:27] offset:4624
    s_waitcnt lgkmcnt(0)
L_A_M1:
    ds_read_b128 v[80:83], v2 offset:1536
    ds_read_b128 v[84:87], v2 offset:1024
    ds_read_b128 v[88:91], v2 offset:1600
    ds_read_b128 v[92:95], v2 offset:1088
    ds_read_b128 v[64:67], v2 offset:1664
    ds_read_b128 v[68:71], v2 offset:1152
    s_waitcnt lgkmcnt(5)
    v_mfma_f32_16x16x32_bf16 v[112:115], v[128:131], v[80:83], v[112:115]
    ds_read_b128 v[72:75], v2 offset:1728
    v_mfma_f32_16x16x32_bf16 v[116:119], v[160:163], v[80:83], v[116:119]
    ds_read_b128 v[76:79], v2 offset:1216
    s_waitcnt lgkmcnt(6)
    v_mfma_f32_16x16x32_bf16 v[116:119], v[128:131], v[84:87], v[116:119]
    v_mfma_f32_16x16x32_bf16 v[120:123], v[160:163], v[84:87], v[120:123]
    s_waitcnt lgkmcnt(5)
    v_mfma_f32_16x16x32_bf16 v[112:115], v[132:135], v[88:91], v[112:115]
    ds_read_b128 v[80:83], v2 offset:1792
    v_mfma_f32_16x16x32_bf16 v[116:119], v[164:167], v[88:91], v[116:119]
    ds_read_b128 v[84:87], v2 offset:1280
    s_waitcnt lgkmcnt(6)
    v_mfma_f32_16x16x32_bf16 v[116:119], v[132:135], v[92:95], v[116:119]
    v_mfma_f32_16x16x32_bf16 v[120:123], v[164:167], v[92:95], v[120:123]
    s_waitcnt lgkmcnt(5)
    v_mfma_f32_16x16x32_bf16 v[112:115], v[136:139], v[64:67], v[112:115]
    ds_read_b128 v[88:91], v2 offset:1856
    v_mfma_f32_16x16x32_bf16 v[116:119], v[168:171], v[64:67], v[116:119]
    s_barrier
    s_setprio 2
    ds_read_b128 v[92:95], v2 offset:1344
    s_waitcnt lgkmcnt(6)
    v_mfma_f32_16x16x32_bf16 v[116:119], v[136:139], v[68:71], v[116:119]
    v_mfma_f32_16x16x32_bf16 v[120:123], v[168:171], v[68:71], v[120:123]
    s_waitcnt lgkmcnt(5)
    v_mfma_f32_16x16x32_bf16 v[112:115], v[140:143], v[72:75], v[112:115]
    ds_read_b128 v[64:67], v2 offset:1920
    v_mfma_f32_16x16x32_bf16 v[116:119], v[172:175], v[72:75], v[116:119]
    ds_read_b128 v[68:71], v2 offset:1408
    s_waitcnt lgkmcnt(6)
    v_mfma_f32_16x16x32_bf16 v[116:119], v[140:143], v[76:79], v[116:119]
    v_mfma_f32_16x16x32_bf16 v[120:123], v[172:175], v[76:79], v[120:123]
    s_waitcnt lgkmcnt(5)
    v_mfma_f32_16x16x32_bf16 v[112:115], v[144:147], v[80:83], v[112:115]
    ds_read_b128 v[72:75], v2 offset:1984
    v_mfma_f32_16x16x32_bf16 v[116:119], v[176:179], v[80:83], v[116:119]
    ds_read_b128 v[76:79], v2 offset:1472
    s_waitcnt lgkmcnt(6)
    v_mfma_f32_16x16x32_bf16 v[116:119], v[144:147], v[84:87], v[116:119]
    v_mfma_f32_16x16x32_bf16 v[120:123], v[176:179], v[84:87], v[120:123]
    s_waitcnt lgkmcnt(5)
    v_mfma_f32_16x16x32_bf16 v[112:115], v[148:151], v[88:91], v[112:115]
    v_mfma_f32_16x16x32_bf16 v[116:119], v[180:183], v[88:91], v[116:119]
    s_waitcnt lgkmcnt(4)
    v_mfma_f32_16x16x32_bf16 v[116:119], v[148:151], v[92:95], v[116:119]
    v_mfma_f32_16x16x32_bf16 v[120:123], v[180:183], v[92:95], v[120:123]
    s_waitcnt lgkmcnt(3)
    v_mfma_f32_16x16x32_bf16 v[112:115], v[152:155], v[64:67], v[112:115]
    v_mfma_f32_16x16x32_bf16 v[116:119], v[184:187], v[64:67], v[116:119]
    s_waitcnt lgkmcnt(2)
    v_mfma_f32_16x16x32_bf16 v[116:119], v[152:155], v[68:71], v[116:119]
    v_mfma_f32_16x16x32_bf16 v[120:123], v[184:187], v[68:71], v[120:123]
    s_waitcnt lgkmcnt(1)
    v_mfma_f32_16x16x32_bf16 v[112:115], v[156:159], v[72:75], v[112:115]
    v_mfma_f32_16x16x32_bf16 v[116:119], v[188:191], v[72:75], v[116:119]
    s_waitcnt lgkmcnt(0)
    v_mfma_f32_16x16x32_bf16 v[116:119], v[156:159], v[76:79], v[116:119]
    v_mfma_f32_16x16x32_bf16 v[120:123], v[188:191], v[76:79], v[120:123]
    s_nop 3
    v_cvt_pk_bf16_f32 v80, v112, v113
    v_cvt_pk_bf16_f32 v81, v114, v115
    ds_write_b64 v4, v[80:81] offset:2048
    v_cvt_pk_bf16_f32 v82, v116, v117
    v_cvt_pk_bf16_f32 v83, v118, v119
    ds_write_b64 v4, v[82:83] offset:2560
    s_waitcnt lgkmcnt(0)
    s_barrier
    s_setprio 0
    s_cmp_eq_u32 s45, 0
    s_cbranch_scc1 L_A_S3
    ds_read_b64_tr_b16 v[84:85], v5 offset:2048
    ds_read_b64_tr_b16 v[86:87], v5 offset:63744
    v_add_u32 v9, 0x00100000, v9
    s_waitcnt lgkmcnt(0)
    global_store_dwordx4 v9, v[84:87], s[38:39]
    ds_read_b64_tr_b16 v[64:65], v5 offset:2560
    ds_read_b64_tr_b16 v[66:67], v5 offset:64256
    v_add_u32 v9, 0x00100000, v9
    s_waitcnt lgkmcnt(0)
    global_store_dwordx4 v9, v[64:67], s[38:39]
    s_nop 1
    v_add_u32 v9, 0x00200000, v9
    s_branch L_A_M2
L_A_S3:
L_A_M2:
    ds_read_b128 v[80:83], v2 offset:512
    ds_read_b128 v[84:87], v2 offset:0
    ds_read_b128 v[52:55], v2 offset:1536
    ds_read_b128 v[56:59], v2 offset:1552
    ds_read_b128 v[88:91], v2 offset:576
    ds_read_b128 v[92:95], v2 offset:64
    ds_read_b128 v[12:15], v2 offset:1024
    ds_read_b128 v[16:19], v2 offset:1040
    s_waitcnt lgkmcnt(7)
    v_mfma_f32_16x16x32_bf16 v[120:123], v[128:131], v[80:83], v[120:123]
    ds_read_b128 v[72:75], v2 offset:640
    v_mfma_f32_16x16x32_bf16 v[124:127], v[160:163], v[80:83], v[124:127]
    ds_read_b128 v[76:79], v2 offset:128
    s_waitcnt lgkmcnt(8)
    v_mfma_f32_16x16x32_bf16 v[124:127], v[128:131], v[84:87], v[124:127]
    s_waitcnt lgkmcnt(7)
    v_mfma_f32_16x16x32_bf16 v[120:123], v[232:235], v[52:55], v[120:123]
    v_mfma_f32_16x16x32_bf16 v[236:239], v[52:55], v[36:39], 0
    s_waitcnt lgkmcnt(6)
    v_mfma_f32_16x16x32_bf16 v[240:243], v[56:59], v[36:39], 0
    v_mfma_f32_16x16x32_bf16 v[244:247], v[52:55], v[40:43], 0
    v_mfma_f32_16x16x32_bf16 v[248:251], v[56:59], v[40:43], 0
    s_waitcnt lgkmcnt(5)
    v_mfma_f32_16x16x32_bf16 v[120:123], v[132:135], v[88:91], v[120:123]
    ds_read_b128 v[80:83], v2 offset:704
    v_mfma_f32_16x16x32_bf16 v[124:127], v[164:167], v[88:91], v[124:127]
    s_barrier
    s_setprio 2
    ds_read_b128 v[84:87], v2 offset:192
    s_waitcnt lgkmcnt(6)
    v_mfma_f32_16x16x32_bf16 v[124:127], v[132:135], v[92:95], v[124:127]
    v_cvt_pk_bf16_f32 v52, v239, v243
    v_cvt_pk_bf16_f32 v53, v238, v242
    s_waitcnt lgkmcnt(3)
    v_mfma_f32_16x16x32_bf16 v[120:123], v[136:139], v[72:75], v[120:123]
    v_cvt_pk_bf16_f32 v54, v237, v241
    v_cvt_pk_bf16_f32 v55, v236, v240
    ds_read_b128 v[88:91], v2 offset:768
    v_mfma_f32_16x16x32_bf16 v[124:127], v[168:171], v[72:75], v[124:127]
    v_cvt_pk_bf16_f32 v56, v247, v251
    v_cvt_pk_bf16_f32 v57, v246, v250
    ds_read_b128 v[92:95], v2 offset:256
    s_waitcnt lgkmcnt(4)
    v_mfma_f32_16x16x32_bf16 v[124:127], v[136:139], v[76:79], v[124:127]
    v_cvt_pk_bf16_f32 v58, v245, v249
    v_cvt_pk_bf16_f32 v59, v244, v248
    v_mfma_f32_16x16x32_bf16 v[124:127], v[232:235], v[12:15], v[124:127]
    v_mfma_f32_16x16x32_bf16 v[236:239], v[12:15], v[36:39], 0
    v_mfma_f32_16x16x32_bf16 v[240:243], v[16:19], v[36:39], 0
    v_mfma_f32_16x16x32_bf16 v[244:247], v[12:15], v[40:43], 0
    v_mfma_f32_16x16x32_bf16 v[248:251], v[16:19], v[40:43], 0
    v_mfma_f32_16x16x32_bf16 v[120:123], v[52:55], v[220:223], v[120:123]
    v_mfma_f32_16x16x32_bf16 v[120:123], v[56:59], v[208:211], v[120:123]
    v_mfma_f32_16x16x32_bf16 v[124:127], v[52:55], v[224:227], v[124:127]
    v_mfma_f32_16x16x32_bf16 v[124:127], v[56:59], v[212:215], v[124:127]
    s_waitcnt lgkmcnt(3)
    v_mfma_f32_16x16x32_bf16 v[120:123], v[140:143], v[80:83], v[120:123]
    v_cvt_pk_bf16_f32 v12, v239, v243
    v_cvt_pk_bf16_f32 v13, v238, v242
    ds_read_b128 v[72:75], v2 offset:832
    v_mfma_f32_16x16x32_bf16 v[124:127], v[172:175], v[80:83], v[124:127]
    v_cvt_pk_bf16_f32 v14, v237, v241
    v_cvt_pk_bf16_f32 v15, v236, v240
    ds_read_b128 v[76:79], v2 offset:320
    s_waitcnt lgkmcnt(4)
    v_mfma_f32_16x16x32_bf16 v[124:127], v[140:143], v[84:87], v[124:127]
    v_cvt_pk_bf16_f32 v16, v247, v251
    v_cvt_pk_bf16_f32 v17, v246, v250
    s_waitcnt lgkmcnt(3)
    v_mfma_f32_16x16x32_bf16 v[120:123], v[144:147], v[88:91], v[120:123]
    v_cvt_pk_bf16_f32 v18, v245, v249
    v_cvt_pk_bf16_f32 v19, v244, v248
    ds_read_b128 v[80:83], v2 offset:896
    v_mfma_f32_16x16x32_bf16 v[124:127], v[176:179], v[88:91], v[124:127]
    ds_read_b128 v[84:87], v2 offset:384
    s_waitcnt lgkmcnt(4)
    v_mfma_f32_16x16x32_bf16 v[124:127], v[144:147], v[92:95], v[124:127]
    s_waitcnt lgkmcnt(3)
    v_mfma_f32_16x16x32_bf16 v[120:123], v[148:151], v[72:75], v[120:123]
    ds_read_b128 v[88:91], v2 offset:960
    v_mfma_f32_16x16x32_bf16 v[124:127], v[180:183], v[72:75], v[124:127]
    ds_read_b128 v[92:95], v2 offset:448
    s_waitcnt lgkmcnt(4)
    v_mfma_f32_16x16x32_bf16 v[124:127], v[148:151], v[76:79], v[124:127]
    v_mfma_f32_16x16x32_bf16 v[124:127], v[12:15], v[220:223], v[124:127]
    v_mfma_f32_16x16x32_bf16 v[124:127], v[16:19], v[208:211], v[124:127]
    s_waitcnt lgkmcnt(3)
    v_mfma_f32_16x16x32_bf16 v[120:123], v[152:155], v[80:83], v[120:123]
    v_mfma_f32_16x16x32_bf16 v[124:127], v[184:187], v[80:83], v[124:127]
    s_waitcnt lgkmcnt(2)
    v_mfma_f32_16x16x32_bf16 v[124:127], v[152:155], v[84:87], v[124:127]
    s_waitcnt lgkmcnt(1)
    v_mfma_f32_16x16x32_bf16 v[120:123], v[156:159], v[88:91], v[120:123]
    v_mfma_f32_16x16x32_bf16 v[124:127], v[188:191], v[88:91], v[124:127]
    s_waitcnt lgkmcnt(0)
    v_mfma_f32_16x16x32_bf16 v[124:127], v[156:159], v[92:95], v[124:127]
    s_nop 4
    v_cvt_pk_bf16_f32 v72, v120, v121
    v_cvt_pk_bf16_f32 v73, v122, v123
    ds_write_b64 v4, v[72:73] offset:3072
    v_cvt_pk_bf16_f32 v74, v124, v125
    v_cvt_pk_bf16_f32 v75, v126, v127
    ds_write_b64 v4, v[74:75] offset:3584
    s_waitcnt lgkmcnt(0)
    s_barrier
    s_setprio 0
    s_cmp_lg_u32 s45, 0
    s_cbranch_scc1 L_A_F
    s_barrier
    v_add_u32 v9, 0x00500000, v9
L_A_F:
    ds_read_b64_tr_b16 v[64:65], v5 offset:3584
    ds_read_b64_tr_b16 v[66:67], v5 offset:65280
    s_waitcnt lgkmcnt(0)
    global_store_dwordx4 v9, v[64:67], s[38:39]
    s_endpgm
.p2align 6
L_B:
    s_xor_b32 s45, s45, 1
    s_cmp_lg_u32 s45, 0
    s_cbranch_scc1 L_B_nf
    s_add_u32 m0, s44, 64
    s_nop 0
    buffer_load_dwordx4 v10, s[52:55], 0 offen offset:2048 lds
    buffer_load_dwordx4 v10, s[52:55], 0 offen offset:3072 lds
L_B_nf:
    v_and_b32 v64, 15, v11
    v_lshrrev_b32 v65, 4, v11
    v_sub_u32 v66, v64, v65
    v_and_b32 v66, 3, v66
    v_and_b32 v67, 12, v64
    v_lshlrev_b32 v67, 2, v67
    v_lshl_add_u32 v66, v66, 1, v67
    s_lshl_b32 s46, s6, 3
    v_add_u32 v72, s46, v66
    global_load_ushort v74, v72, s[32:33]
    global_load_ushort v75, v72, s[32:33] offset:8
    s_mov_b32 s48, s28
    s_mov_b32 s49, s29
    s_mov_b32 s50, 0x400000
    s_mov_b32 s51, 0x20000
    v_lshl_add_u32 v66, v64, 2, v65
    s_lshl_b32 s46, s4, 17
    s_lshl_b32 s47, s6, 1
    s_add_u32 s46, s46, s47
    v_lshl_add_u32 v6, v66, 11, s46
    v_add_u32 v66, -1, v66
    v_add_u32 v7, 0xffffe000, v6
    v_cmp_gt_u32 vcc, 3, v66
    v_mov_b32 v67, 0x80000000
    s_nop 0
    v_cndmask_b32 v7, v67, v7, vcc
    v_mul_u32_u24 v66, 35744, v65
    v_lshlrev_b32 v67, 3, v64
    v_sub_u32 v66, v66, v67
    s_lshl_b32 s46, s4, 7
    s_sub_u32 s46, 9222, s46
    v_add_u32 v3, s46, v66
    v_add_u32 v66, 1, v64
    v_and_b32 v67, 1, v66
    v_and_b32 v66, 30, v66
    v_mul_u32_u24 v67, 4224, v67
    v_lshl_add_u32 v66, v66, 2, v67
    v_and_b32 v68, 48, v11
    v_add3_u32 v1, v66, v68, s44
    v_cmp_ne_u32 vcc, 0, v67
    v_mov_b32 v0, 2120
    v_mov_b32 v73, 2048
    v_cndmask_b32 v0, v73, v0, vcc
    v_add_u32 v0, v0, v1
    v_mov_b32 v73, 256
    v_cndmask_b32 v73, 0, v73, vcc
    v_add_u32 v73, v73, v1
    v_and_b32 v66, 1, v11
    v_mul_u32_u24 v66, 4576, v66
    v_and_b32 v67, 14, v11
    v_lshlrev_b32 v67, 5, v67
    v_sub_u32 v66, v66, v67
    s_add_u32 s46, s44, 9168
    v_add3_u32 v2, v66, v68, s46
    s_mul_i32 s46, s4, 2112
    s_add_u32 s46, s46, 142976
    v_lshl_add_u32 v4, v11, 3, s46
    s_lshl_b32 s46, s4, 7
    s_add_u32 s46, s46, 142464
    v_bfe_u32 v66, v11, 2, 2
    v_mul_u32_u24 v66, 2112, v66
    v_lshrrev_b32 v67, 4, v11
    v_lshl_add_u32 v66, v67, 5, v66
    v_and_b32 v67, 3, v11
    v_lshl_add_u32 v66, v67, 3, v66
    v_add_u32 v5, s46, v66
    s_lshl_b32 s46, s4, 6
    s_and_b32 s46, s46, 0x100
    s_and_b32 s47, s4, 3
    s_lshl_b32 s47, s47, 3
    s_add_u32 s46, s46, s47
    v_lshrrev_b32 v66, 3, v11
    v_lshlrev_b32 v66, 5, v66
    v_lshl_add_u32 v66, v67, 1, v66
    v_bfe_u32 v67, v11, 2, 1
    v_add3_u32 v66, v66, v67, s46
    s_lshl_b32 s47, s6, 1
    v_lshl_add_u32 v8, v66, 11, s47
    s_add_u32 s47, s47, 2048
    v_lshl_add_u32 v9, v66, 12, s47
    v_mov_b32 v80, 0
    v_mov_b32 v81, 0
    v_mov_b32 v82, 0
    v_mov_b32 v83, 0
    v_and_b32 v66, 31, v11
    v_min_u32 v66, 27, v66
    v_lshrrev_b32 v67, 5, v11
    v_mul_u32_u24 v67, 4576, v67
    v_lshl_add_u32 v66, v66, 4, v67
    v_add_u32 v66, s44, v66
    v_mov_b32 v67, s44
    ds_write_b128 v66, v[80:83] offset:12816
    ds_write_b16 v67, v80 offset:12814
    v_min_u32 v60, 32, v11
    v_cmp_lt_u32 vcc, 16, v60
    v_mov_b32 v67, 4156
    s_mov_b32 s56, 0x00010000
    s_mov_b32 s57, -1
    v_cndmask_b32 v67, 0, v67, vcc
    v_lshl_add_u32 v67, v60, 2, v67
    v_add_u32 v60, s44, v67
    v_mov_b32 v11, v73
    s_mov_b32 s96, 0x000f000f
    s_mov_b32 s97, 0x000f000f
    s_mov_b32 s98, 0x00f000f0
    s_mov_b32 s99, 0x00f000f0
    s_mov_b32 s100, 0x0f000f00
    s_mov_b32 s101, 0x0f000f00
    s_mov_b32 s58, 0xf000f000
    s_mov_b32 s59, 0xf000f000
    s_mov_b32 s40, 0xeeeeffff
    s_mov_b32 s41, 0x8888cccc
    s_mov_b32 s42, 0x22221111
    s_mov_b32 s43, 0x88884444
    v_mov_b32 v66, 0x3f80
    v_mov_b32 v67, 1.0
    v_cndmask_b32 v66, 0, v66, s[42:43]
    v_cndmask_b32 v67, 0, v67, s[42:43]
    v_cndmask_b32 v28, 0, v66, s[96:97]
    v_cndmask_b32 v29, 0, v66, s[98:99]
    v_cndmask_b32 v30, 0, v66, s[100:101]
    v_cndmask_b32 v31, 0, v66, s[58:59]
    v_cndmask_b32 v32, 0, v67, s[96:97]
    v_cndmask_b32 v33, 0, v67, s[98:99]
    v_cndmask_b32 v34, 0, v67, s[100:101]
    v_cndmask_b32 v35, 0, v67, s[58:59]
    s_barrier
    global_load_dwordx4 v[36:39], v6, s[28:29]
    buffer_load_dwordx4 v[44:47], v7, s[48:51], 0 offen
    global_load_dwordx4 v[40:43], v6, s[30:31]
    s_waitcnt vmcnt(3)
    v_lshlrev_b32 v75, 16, v75
    v_cndmask_b32 v66, 0, v74, s[40:41]
    v_cndmask_b32 v67, 0, v75, s[40:41]
    v_sub_u32 v74, v74, v66
    v_sub_u32 v75, v75, v67
    v_cndmask_b32 v12, 0, v66, s[96:97]
    v_cndmask_b32 v13, 0, v66, s[98:99]
    v_cndmask_b32 v14, 0, v66, s[100:101]
    v_cndmask_b32 v15, 0, v66, s[58:59]
    v_cndmask_b32 v20, 0, v74, s[96:97]
    v_cndmask_b32 v21, 0, v74, s[98:99]
    v_cndmask_b32 v22, 0, v74, s[100:101]
    v_cndmask_b32 v23, 0, v74, s[58:59]
    v_cndmask_b32 v16, 0, v67, s[96:97]
    v_cndmask_b32 v17, 0, v67, s[98:99]
    v_cndmask_b32 v18, 0, v67, s[100:101]
    v_cndmask_b32 v19, 0, v67, s[58:59]
    v_cndmask_b32 v24, 0, v75, s[96:97]
    v_cndmask_b32 v25, 0, v75, s[98:99]
    v_cndmask_b32 v26, 0, v75, s[100:101]
    v_cndmask_b32 v27, 0, v75, s[58:59]
    v_lshlrev_b32 v66, 16, v76
    v_lshlrev_b32 v77, 16, v77
    v_and_b32 v76, 0xffff0000, v76
    v_add_f32 v66, v66, v77
    v_cvt_pk_bf16_f32 v66, v66, v76
    v_cndmask_b32 v61, 0, v66, s[56:57]
    s_mov_b32 m0, s44
    s_nop 0
    ds_read_addtid_b32 v96 offset:64
    ds_read_addtid_b32 v97 offset:320
    ds_read_addtid_b32 v98 offset:576
    ds_read_addtid_b32 v99 offset:832
    ds_read_addtid_b32 v100 offset:1088
    ds_read_addtid_b32 v101 offset:1344
    ds_read_addtid_b32 v102 offset:1600
    ds_read_addtid_b32 v103 offset:1856
    s_waitcnt lgkmcnt(0)
    ds_write_addtid_b32 v96 offset:4284
    ds_write_addtid_b32 v97 offset:4540
    ds_write_addtid_b32 v98 offset:4796
    ds_write_addtid_b32 v99 offset:5052
    ds_write_addtid_b32 v100 offset:5308
    ds_write_addtid_b32 v101 offset:5564
    ds_write_addtid_b32 v102 offset:5820
    ds_write_addtid_b32 v103 offset:6076
    ds_write_b32 v60, v61
    ds_read_b64 v[128:129], v1 offset:0
    ds_read_b64 v[130:131], v1 offset:8
    ds_read_b64 v[160:161], v1 offset:512
    ds_read_b64 v[162:163], v1 offset:520
    ds_read_b64 v[192:193], v1 offset:1024
    ds_read_b64 v[194:195], v1 offset:1032
    ds_read_b64 v[224:225], v1 offset:1536
    ds_read_b64 v[226:227], v1 offset:1544
    ds_read_b64 v[132:133], v1 offset:64
    ds_read_b64 v[134:135], v1 offset:72
    ds_read_b64 v[164:165], v1 offset:576
    ds_read_b64 v[166:167], v1 offset:584
    ds_read_b64 v[196:197], v1 offset:1088
    ds_read_b64 v[198:199], v1 offset:1096
    ds_read_b64 v[228:229], v1 offset:1600
    ds_read_b64 v[230:231], v1 offset:1608
    ds_read_b64 v[136:137], v1 offset:128
    ds_read_b64 v[138:139], v1 offset:136
    ds_read_b64 v[168:169], v1 offset:640
    ds_read_b64 v[170:171], v1 offset:648
    ds_read_b64 v[200:201], v1 offset:1152
    ds_read_b64 v[202:203], v1 offset:1160
    ds_read_b64 v[232:233], v1 offset:1664
    ds_read_b64 v[234:235], v1 offset:1672
    ds_read_b64 v[140:141], v1 offset:192
    ds_read_b64 v[142:143], v1 offset:200
    ds_read_b64 v[172:173], v1 offset:704
    ds_read_b64 v[174:175], v1 offset:712
    ds_read_b64 v[204:205], v1 offset:1216
    ds_read_b64 v[206:207], v1 offset:1224
    ds_read_b64 v[236:237], v1 offset:1728
    ds_read_b64 v[238:239], v1 offset:1736
    ds_read_b64 v[144:145], v1 offset:256
    ds_read_b64 v[146:147], v1 offset:264
    ds_read_b64 v[176:177], v1 offset:768
    ds_read_b64 v[178:179], v1 offset:776
    ds_read_b64 v[208:209], v1 offset:1280
    ds_read_b64 v[210:211], v1 offset:1288
    ds_read_b64 v[240:241], v1 offset:1792
    ds_read_b64 v[242:243], v1 offset:1800
    ds_read_b64 v[148:149], v1 offset:320
    ds_read_b64 v[150:151], v1 offset:328
    ds_read_b64 v[180:181], v1 offset:832
    ds_read_b64 v[182:183], v1 offset:840
    ds_read_b64 v[212:213], v1 offset:1344
    ds_read_b64 v[214:215], v1 offset:1352
    ds_read_b64 v[244:245], v1 offset:1856
    ds_read_b64 v[246:247], v1 offset:1864
    ds_read_b64 v[152:153], v1 offset:384
    ds_read_b64 v[154:155], v1 offset:392
    ds_read_b64 v[184:185], v1 offset:896
    ds_read_b64 v[186:187], v1 offset:904
    ds_read_b64 v[216:217], v1 offset:1408
    ds_read_b64 v[218:219], v1 offset:1416
    ds_read_b64 v[248:249], v1 offset:1920
    ds_read_b64 v[250:251], v1 offset:1928
    ds_read_b64 v[156:157], v1 offset:448
    ds_read_b64 v[158:159], v1 offset:456
    ds_read_b64 v[188:189], v1 offset:960
    ds_read_b64 v[190:191], v1 offset:968
    ds_read_b64 v[220:221], v1 offset:1472
    ds_read_b64 v[222:223], v1 offset:1480
    ds_read_b64 v[252:253], v1 offset:1984
    ds_read_b64 v[254:255], v1 offset:1992
    s_cmp_lg_u32 s45, 0
    s_cbranch_scc1 L_B_lc
    s_mov_b32 m0, s44
    s_nop 0
    ds_read_addtid_b32 v104 offset:2048
    ds_read_addtid_b32 v105 offset:2304
    ds_read_addtid_b32 v106 offset:2560
    ds_read_addtid_b32 v107 offset:2816
    ds_read_addtid_b32 v108 offset:3072
    ds_read_addtid_b32 v109 offset:3072
    ds_read_addtid_b32 v110 offset:3328
    ds_read_addtid_b32 v111 offset:3584
    ds_read_addtid_b32 v112 offset:3840
    ds_read_addtid_b32 v113 offset:3904
    s_waitcnt lgkmcnt(0)
    ds_write_addtid_b32 v104 offset:6340
    ds_write_addtid_b32 v105 offset:6596
    ds_write_addtid_b32 v106 offset:6852
    ds_write_addtid_b32 v107 offset:7108
    ds_write_addtid_b32 v108 offset:7364
    ds_write_addtid_b32 v109 offset:7548
    ds_write_addtid_b32 v110 offset:7804
    ds_write_addtid_b32 v111 offset:8060
    ds_write_addtid_b32 v112 offset:8316
    ds_write_addtid_b32 v113 offset:8380
L_B_lc:
    s_waitcnt vmcnt(1)
    v_mov_b32_dpp v44, v36 row_shr:1 row_mask:0xf bank_mask:0xf
    v_mov_b32_dpp v45, v37 row_shr:1 row_mask:0xf bank_mask:0xf
    v_mov_b32_dpp v46, v38 row_shr:1 row_mask:0xf bank_mask:0xf
    v_mov_b32_dpp v47, v39 row_shr:1 row_mask:0xf bank_mask:0xf
    s_waitcnt vmcnt(0)
    v_mov_b32 v80, v40
    v_mfma_f32_16x16x32_bf16 v[64:67], v[12:15], v[36:39], 0
    v_mfma_f32_16x16x32_bf16 v[68:71], v[16:19], v[36:39], 0
    v_mfma_f32_16x16x32_bf16 v[72:75], v[28:31], v[40:43], 0
    v_mfma_f32_16x16x32_bf16 v[64:67], v[20:23], v[44:47], v[64:67]
    v_mfma_f32_16x16x32_bf16 v[68:71], v[24:27], v[44:47], v[68:71]
    v_mfma_f32_16x16x32_bf16 v[76:79], v[32:35], v[40:43], 0
    s_nop 5
    v_mul_f32 v64, v64, v72
    v_mul_f32 v65, v65, v73
    v_mul_f32 v66, v66, v74
    v_mul_f32 v67, v67, v75
    v_cvt_pk_bf16_f32 v80, v67, v66
    v_cvt_pk_bf16_f32 v81, v65, v64
    v_cvt_pk_bf16_f32 v82, v66, v65
    v_mul_f32 v68, v68, v76
    ds_write_b64 v3, v[80:81] offset:8162
    v_mul_f32 v69, v69, v77
    ds_write_b16 v3, v80 offset:3584
    v_mul_f32 v70, v70, v78
    v_mul_f32 v71, v71, v79
    ds_write_b32 v3, v82 offset:3586
    v_cvt_pk_bf16_f32 v84, v71, v70
    v_cvt_pk_bf16_f32 v85, v69, v68
    ds_write_b16_d16_hi v3, v81 offset:3590
    v_cvt_pk_bf16_f32 v86, v70, v69
    ds_write_b64 v3, v[84:85] offset:26034
    ds_write_b16 v3, v84 offset:21456
    ds_write_b32 v3, v86 offset:21458
    ds_write_b16_d16_hi v3, v85 offset:21462
    s_cmp_eq_u32 s45, 0
    s_cbranch_scc1 L_B_pj
    v_add_u32 v6, 0x00100000, v6
    v_add_u32 v7, 0x00100000, v7
    global_load_dwordx4 v[48:51], v6, s[28:29]
    buffer_load_dwordx4 v[56:59], v7, s[48:51], 0 offen
    global_load_dwordx4 v[52:55], v6, s[30:31]
    s_add_u32 m0, s44, 64
    s_nop 0
    buffer_load_dwordx4 v10, s[52:55], 0 offen offset:2048 lds
    buffer_load_dwordx4 v10, s[52:55], 0 offen offset:3072 lds
L_B_pj:
    s_waitcnt lgkmcnt(0)
    s_barrier
    s_cmp_eq_u32 s45, 0
    s_cbranch_scc1 L_B_M0
    v_add_u32 v6, 0x00080000, v6
    v_add_u32 v7, 0x00080000, v7
    global_load_dwordx4 v[36:39], v6, s[28:29]
    buffer_load_dwordx4 v[44:47], v7, s[48:51], 0 offen
    global_load_dwordx4 v[40:43], v6, s[30:31]
    s_waitcnt vmcnt(6)
    v_mov_b32_dpp v56, v48 row_shr:1 row_mask:0xf bank_mask:0xf
    v_mov_b32_dpp v57, v49 row_shr:1 row_mask:0xf bank_mask:0xf
    v_mov_b32_dpp v58, v50 row_shr:1 row_mask:0xf bank_mask:0xf
    v_mov_b32_dpp v59, v51 row_shr:1 row_mask:0xf bank_mask:0xf
    s_waitcnt vmcnt(5)
    v_mov_b32 v80, v52
    s_setprio 3
    v_mfma_f32_16x16x32_bf16 v[64:67], v[12:15], v[48:51], 0
    v_mfma_f32_16x16x32_bf16 v[68:71], v[16:19], v[48:51], 0
    v_mfma_f32_16x16x32_bf16 v[72:75], v[28:31], v[52:55], 0
    v_mfma_f32_16x16x32_bf16 v[64:67], v[20:23], v[56:59], v[64:67]
    v_mfma_f32_16x16x32_bf16 v[68:71], v[24:27], v[56:59], v[68:71]
    v_mfma_f32_16x16x32_bf16 v[76:79], v[32:35], v[52:55], 0
    s_setprio 0
    s_nop 4
    v_mul_f32 v64, v64, v72
    v_mul_f32 v65, v65, v73
    v_mul_f32 v66, v66, v74
    v_mul_f32 v67, v67, v75
    v_cvt_pk_bf16_f32 v80, v67, v66
    v_cvt_pk_bf16_f32 v81, v65, v64
    v_cvt_pk_bf16_f32 v82, v66, v65
    v_mul_f32 v68, v68, v76
    ds_write_b64 v3, v[80:81] offset:7138
    v_mul_f32 v69, v69, v77
    ds_write_b16 v3, v80 offset:2560
    v_mul_f32 v70, v70, v78
    v_mul_f32 v71, v71, v79
    ds_write_b32 v3, v82 offset:2562
    v_cvt_pk_bf16_f32 v84, v71, v70
    v_cvt_pk_bf16_f32 v85, v69, v68
    ds_write_b16_d16_hi v3, v81 offset:2566
    v_cvt_pk_bf16_f32 v86, v70, v69
    ds_write_b64 v3, v[84:85] offset:25010
    ds_write_b16 v3, v84 offset:20432
    ds_write_b32 v3, v86 offset:20434
    ds_write_b16_d16_hi v3, v85 offset:20438
    v_add_u32 v6, 0x00080000, v6
    v_add_u32 v7, 0x00080000, v7
    global_load_dwordx4 v[48:51], v6, s[28:29]
    buffer_load_dwordx4 v[56:59], v7, s[48:51], 0 offen
    global_load_dwordx4 v[52:55], v6, s[30:31]
    s_waitcnt vmcnt(6)
    s_mov_b32 m0, s44
    s_nop 0
    ds_read_addtid_b32 v96 offset:2048
    ds_read_addtid_b32 v97 offset:2304
    ds_read_addtid_b32 v98 offset:2560
    ds_read_addtid_b32 v99 offset:2816
    ds_read_addtid_b32 v100 offset:3072
    ds_read_addtid_b32 v101 offset:3072
    ds_read_addtid_b32 v102 offset:3328
    ds_read_addtid_b32 v103 offset:3584
    ds_read_addtid_b32 v104 offset:3840
    ds_read_addtid_b32 v105 offset:3904
    s_waitcnt lgkmcnt(0)
    ds_write_addtid_b32 v96 offset:6340
    ds_write_addtid_b32 v97 offset:6596
    ds_write_addtid_b32 v98 offset:6852
    ds_write_addtid_b32 v99 offset:7108
    ds_write_addtid_b32 v100 offset:7364
    ds_write_addtid_b32 v101 offset:7548
    ds_write_addtid_b32 v102 offset:7804
    ds_write_addtid_b32 v103 offset:8060
    ds_write_addtid_b32 v104 offset:8316
    ds_write_addtid_b32 v105 offset:8380
    s_waitcnt vmcnt(4)
    v_mov_b32_dpp v44, v36 row_shr:1 row_mask:0xf bank_mask:0xf
    v_mov_b32_dpp v45, v37 row_shr:1 row_mask:0xf bank_mask:0xf
    v_mov_b32_dpp v46, v38 row_shr:1 row_mask:0xf bank_mask:0xf
    v_mov_b32_dpp v47, v39 row_shr:1 row_mask:0xf bank_mask:0xf
    s_waitcnt vmcnt(3)
    v_mov_b32 v80, v40
    s_setprio 3
    v_mfma_f32_16x16x32_bf16 v[64:67], v[12:15], v[36:39], 0
    v_mfma_f32_16x16x32_bf16 v[68:71], v[16:19], v[36:39], 0
    v_mfma_f32_16x16x32_bf16 v[72:75], v[28:31], v[40:43], 0
    v_mfma_f32_16x16x32_bf16 v[64:67], v[20:23], v[44:47], v[64:67]
    v_mfma_f32_16x16x32_bf16 v[68:71], v[24:27], v[44:47], v[68:71]
    v_mfma_f32_16x16x32_bf16 v[76:79], v[32:35], v[40:43], 0
    s_setprio 0
    s_nop 4
    v_mul_f32 v64, v64, v72
    v_mul_f32 v65, v65, v73
    v_mul_f32 v66, v66, v74
    v_mul_f32 v67, v67, v75
    v_cvt_pk_bf16_f32 v80, v67, v66
    v_cvt_pk_bf16_f32 v81, v65, v64
    v_cvt_pk_bf16_f32 v82, v66, v65
    v_mul_f32 v68, v68, v76
    ds_write_b64 v3, v[80:81] offset:6626
    v_mul_f32 v69, v69, v77
    ds_write_b16 v3, v80 offset:2048
    v_mul_f32 v70, v70, v78
    v_mul_f32 v71, v71, v79
    ds_write_b32 v3, v82 offset:2050
    v_cvt_pk_bf16_f32 v84, v71, v70
    v_cvt_pk_bf16_f32 v85, v69, v68
    ds_write_b16_d16_hi v3, v81 offset:2054
    v_cvt_pk_bf16_f32 v86, v70, v69
    ds_write_b64 v3, v[84:85] offset:24498
    ds_write_b16 v3, v84 offset:19920
    ds_write_b32 v3, v86 offset:19922
    ds_write_b16_d16_hi v3, v85 offset:19926
    global_load_dwordx4 v[60:63], v8, s[26:27]
    s_waitcnt lgkmcnt(0)
L_B_M0:
    ds_read_b128 v[80:83], v2 offset:3584
    ds_read_b128 v[84:87], v2 offset:3072
    s_waitcnt lgkmcnt(1)
    v_mfma_f32_16x16x32_bf16 v[96:99], v[128:131], v[80:83], 0
    ds_read2_b64 v[64:67], v0 offset0:0 offset1:1
    v_mfma_f32_16x16x32_bf16 v[100:103], v[160:163], v[80:83], 0
    ds_read2_b64 v[68:71], v0 offset0:64 offset1:65
    s_waitcnt lgkmcnt(2)
    v_mfma_f32_16x16x32_bf16 v[100:103], v[128:131], v[84:87], v[100:103]
    ds_read_b64 v[72:73], v11 offset:3072
    v_mfma_f32_16x16x32_bf16 v[104:107], v[160:163], v[84:87], 0
    s_cmp_eq_u32 s45, 0
    s_cbranch_scc1 L_B_nb
    s_barrier
L_B_nb:
    s_setprio 2
    ds_read_b64 v[74:75], v11 offset:3080
    v_mfma_f32_16x16x32_bf16 v[104:107], v[192:195], v[80:83], v[104:107]
    ds_read_b64 v[76:77], v11 offset:3584
    v_mfma_f32_16x16x32_bf16 v[108:111], v[224:227], v[80:83], 0
    ds_read_b64 v[78:79], v11 offset:3592
    v_mfma_f32_16x16x32_bf16 v[108:111], v[192:195], v[84:87], v[108:111]
    ds_read_b128 v[88:91], v2 offset:3648
    v_mfma_f32_16x16x32_bf16 v[112:115], v[224:227], v[84:87], 0
    ds_read_b128 v[92:95], v2 offset:3136
    s_waitcnt lgkmcnt(7)
    v_mfma_f32_16x16x32_bf16 v[112:115], v[64:67], v[80:83], v[112:115]
    v_mfma_f32_16x16x32_bf16 v[116:119], v[64:67], v[84:87], 0
    ds_read2_b64 v[64:67], v0 offset0:8 offset1:9
    s_waitcnt lgkmcnt(7)
    v_mfma_f32_16x16x32_bf16 v[116:119], v[68:71], v[80:83], v[116:119]
    v_mfma_f32_16x16x32_bf16 v[120:123], v[68:71], v[84:87], 0
    ds_read2_b64 v[68:71], v0 offset0:72 offset1:73
    s_waitcnt lgkmcnt(6)
    v_mfma_f32_16x16x32_bf16 v[120:123], v[72:75], v[80:83], v[120:123]
    v_mfma_f32_16x16x32_bf16 v[124:127], v[72:75], v[84:87], 0
    ds_read_b64 v[72:73], v11 offset:3136
    s_waitcnt lgkmcnt(5)
    v_mfma_f32_16x16x32_bf16 v[124:127], v[76:79], v[80:83], v[124:127]
    ds_read_b64 v[74:75], v11 offset:3144
    s_waitcnt lgkmcnt(5)
    v_mfma_f32_16x16x32_bf16 v[96:99], v[132:135], v[88:91], v[96:99]
    ds_read_b64 v[76:77], v11 offset:3648
    v_mfma_f32_16x16x32_bf16 v[100:103], v[164:167], v[88:91], v[100:103]
    ds_read_b64 v[78:79], v11 offset:3656
    s_waitcnt lgkmcnt(6)
    v_mfma_f32_16x16x32_bf16 v[100:103], v[132:135], v[92:95], v[100:103]
    ds_read_b128 v[80:83], v2 offset:3712
    v_mfma_f32_16x16x32_bf16 v[104:107], v[164:167], v[92:95], v[104:107]
    ds_read_b128 v[84:87], v2 offset:3200
    v_mfma_f32_16x16x32_bf16 v[104:107], v[196:199], v[88:91], v[104:107]
    v_mfma_f32_16x16x32_bf16 v[108:111], v[228:231], v[88:91], v[108:111]
    v_mfma_f32_16x16x32_bf16 v[108:111], v[196:199], v[92:95], v[108:111]
    v_mfma_f32_16x16x32_bf16 v[112:115], v[228:231], v[92:95], v[112:115]
    s_waitcnt lgkmcnt(7)
    v_mfma_f32_16x16x32_bf16 v[112:115], v[64:67], v[88:91], v[112:115]
    v_mfma_f32_16x16x32_bf16 v[116:119], v[64:67], v[92:95], v[116:119]
    ds_read2_b64 v[64:67], v0 offset0:16 offset1:17
    s_waitcnt lgkmcnt(7)
    v_mfma_f32_16x16x32_bf16 v[116:119], v[68:71], v[88:91], v[116:119]
    v_mfma_f32_16x16x32_bf16 v[120:123], v[68:71], v[92:95], v[120:123]
    ds_read2_b64 v[68:71], v0 offset0:80 offset1:81
    s_waitcnt lgkmcnt(6)
    v_mfma_f32_16x16x32_bf16 v[120:123], v[72:75], v[88:91], v[120:123]
    v_mfma_f32_16x16x32_bf16 v[124:127], v[72:75], v[92:95], v[124:127]
    ds_read_b64 v[72:73], v11 offset:3200
    s_waitcnt lgkmcnt(5)
    v_mfma_f32_16x16x32_bf16 v[124:127], v[76:79], v[88:91], v[124:127]
    ds_read_b64 v[74:75], v11 offset:3208
    s_waitcnt lgkmcnt(5)
    v_mfma_f32_16x16x32_bf16 v[96:99], v[136:139], v[80:83], v[96:99]
    ds_read_b64 v[76:77], v11 offset:3712
    v_mfma_f32_16x16x32_bf16 v[100:103], v[168:171], v[80:83], v[100:103]
    ds_read_b64 v[78:79], v11 offset:3720
    s_waitcnt lgkmcnt(6)
    v_mfma_f32_16x16x32_bf16 v[100:103], v[136:139], v[84:87], v[100:103]
    ds_read_b128 v[88:91], v2 offset:3776
    v_mfma_f32_16x16x32_bf16 v[104:107], v[168:171], v[84:87], v[104:107]
    ds_read_b128 v[92:95], v2 offset:3264
    v_mfma_f32_16x16x32_bf16 v[104:107], v[200:203], v[80:83], v[104:107]
    v_mfma_f32_16x16x32_bf16 v[108:111], v[232:235], v[80:83], v[108:111]
    v_mfma_f32_16x16x32_bf16 v[108:111], v[200:203], v[84:87], v[108:111]
    v_mfma_f32_16x16x32_bf16 v[112:115], v[232:235], v[84:87], v[112:115]
    s_waitcnt lgkmcnt(7)
    v_mfma_f32_16x16x32_bf16 v[112:115], v[64:67], v[80:83], v[112:115]
    v_mfma_f32_16x16x32_bf16 v[116:119], v[64:67], v[84:87], v[116:119]
    ds_read2_b64 v[64:67], v0 offset0:24 offset1:25
    s_waitcnt lgkmcnt(7)
    v_mfma_f32_16x16x32_bf16 v[116:119], v[68:71], v[80:83], v[116:119]
    v_mfma_f32_16x16x32_bf16 v[120:123], v[68:71], v[84:87], v[120:123]
    ds_read2_b64 v[68:71], v0 offset0:88 offset1:89
    s_waitcnt lgkmcnt(6)
    v_mfma_f32_16x16x32_bf16 v[120:123], v[72:75], v[80:83], v[120:123]
    v_mfma_f32_16x16x32_bf16 v[124:127], v[72:75], v[84:87], v[124:127]
    ds_read_b64 v[72:73], v11 offset:3264
    s_waitcnt lgkmcnt(5)
    v_mfma_f32_16x16x32_bf16 v[124:127], v[76:79], v[80:83], v[124:127]
    ds_read_b64 v[74:75], v11 offset:3272
    s_waitcnt lgkmcnt(5)
    v_mfma_f32_16x16x32_bf16 v[96:99], v[140:143], v[88:91], v[96:99]
    ds_read_b64 v[76:77], v11 offset:3776
    v_mfma_f32_16x16x32_bf16 v[100:103], v[172:175], v[88:91], v[100:103]
    ds_read_b64 v[78:79], v11 offset:3784
    s_waitcnt lgkmcnt(6)
    v_mfma_f32_16x16x32_bf16 v[100:103], v[140:143], v[92:95], v[100:103]
    ds_read_b128 v[80:83], v2 offset:3840
    v_mfma_f32_16x16x32_bf16 v[104:107], v[172:175], v[92:95], v[104:107]
    ds_read_b128 v[84:87], v2 offset:3328
    v_mfma_f32_16x16x32_bf16 v[104:107], v[204:207], v[88:91], v[104:107]
    v_mfma_f32_16x16x32_bf16 v[108:111], v[236:239], v[88:91], v[108:111]
    v_mfma_f32_16x16x32_bf16 v[108:111], v[204:207], v[92:95], v[108:111]
    v_mfma_f32_16x16x32_bf16 v[112:115], v[236:239], v[92:95], v[112:115]
    s_waitcnt lgkmcnt(7)
    v_mfma_f32_16x16x32_bf16 v[112:115], v[64:67], v[88:91], v[112:115]
    v_mfma_f32_16x16x32_bf16 v[116:119], v[64:67], v[92:95], v[116:119]
    ds_read2_b64 v[64:67], v0 offset0:32 offset1:33
    s_waitcnt lgkmcnt(7)
    v_mfma_f32_16x16x32_bf16 v[116:119], v[68:71], v[88:91], v[116:119]
    v_mfma_f32_16x16x32_bf16 v[120:123], v[68:71], v[92:95], v[120:123]
    ds_read2_b64 v[68:71], v0 offset0:96 offset1:97
    s_waitcnt lgkmcnt(6)
    v_mfma_f32_16x16x32_bf16 v[120:123], v[72:75], v[88:91], v[120:123]
    v_mfma_f32_16x16x32_bf16 v[124:127], v[72:75], v[92:95], v[124:127]
    ds_read_b64 v[72:73], v11 offset:3328
    s_waitcnt lgkmcnt(5)
    v_mfma_f32_16x16x32_bf16 v[124:127], v[76:79], v[88:91], v[124:127]
    ds_read_b64 v[74:75], v11 offset:3336
    s_waitcnt lgkmcnt(5)
    v_mfma_f32_16x16x32_bf16 v[96:99], v[144:147], v[80:83], v[96:99]
    ds_read_b64 v[76:77], v11 offset:3840
    v_mfma_f32_16x16x32_bf16 v[100:103], v[176:179], v[80:83], v[100:103]
    ds_read_b64 v[78:79], v11 offset:3848
    s_waitcnt lgkmcnt(6)
    v_mfma_f32_16x16x32_bf16 v[100:103], v[144:147], v[84:87], v[100:103]
    ds_read_b128 v[88:91], v2 offset:3904
    v_mfma_f32_16x16x32_bf16 v[104:107], v[176:179], v[84:87], v[104:107]
    ds_read_b128 v[92:95], v2 offset:3392
    v_mfma_f32_16x16x32_bf16 v[104:107], v[208:211], v[80:83], v[104:107]
    v_mfma_f32_16x16x32_bf16 v[108:111], v[240:243], v[80:83], v[108:111]
    v_mfma_f32_16x16x32_bf16 v[108:111], v[208:211], v[84:87], v[108:111]
    v_mfma_f32_16x16x32_bf16 v[112:115], v[240:243], v[84:87], v[112:115]
    s_waitcnt lgkmcnt(7)
    v_mfma_f32_16x16x32_bf16 v[112:115], v[64:67], v[80:83], v[112:115]
    v_mfma_f32_16x16x32_bf16 v[116:119], v[64:67], v[84:87], v[116:119]
    ds_read2_b64 v[64:67], v0 offset0:40 offset1:41
    s_waitcnt lgkmcnt(7)
    v_mfma_f32_16x16x32_bf16 v[116:119], v[68:71], v[80:83], v[116:119]
    v_mfma_f32_16x16x32_bf16 v[120:123], v[68:71], v[84:87], v[120:123]
    ds_read2_b64 v[68:71], v0 offset0:104 offset1:105
    s_waitcnt lgkmcnt(6)
    v_mfma_f32_16x16x32_bf16 v[120:123], v[72:75], v[80:83], v[120:123]
    v_mfma_f32_16x16x32_bf16 v[124:127], v[72:75], v[84:87], v[124:127]
    ds_read_b64 v[72:73], v11 offset:3392
    s_waitcnt lgkmcnt(5)
    v_mfma_f32_16x16x32_bf16 v[124:127], v[76:79], v[80:83], v[124:127]
    ds_read_b64 v[74:75], v11 offset:3400
    s_waitcnt lgkmcnt(5)
    v_mfma_f32_16x16x32_bf16 v[96:99], v[148:151], v[88:91], v[96:99]
    ds_read_b64 v[76:77], v11 offset:3904
    v_mfma_f32_16x16x32_bf16 v[100:103], v[180:183], v[88:91], v[100:103]
    ds_read_b64 v[78:79], v11 offset:3912
    s_waitcnt lgkmcnt(6)
    v_mfma_f32_16x16x32_bf16 v[100:103], v[148:151], v[92:95], v[100:103]
    ds_read_b128 v[80:83], v2 offset:3968
    v_mfma_f32_16x16x32_bf16 v[104:107], v[180:183], v[92:95], v[104:107]
    ds_read_b128 v[84:87], v2 offset:3456
    v_mfma_f32_16x16x32_bf16 v[104:107], v[212:215], v[88:91], v[104:107]
    v_mfma_f32_16x16x32_bf16 v[108:111], v[244:247], v[88:91], v[108:111]
    v_mfma_f32_16x16x32_bf16 v[108:111], v[212:215], v[92:95], v[108:111]
    v_mfma_f32_16x16x32_bf16 v[112:115], v[244:247], v[92:95], v[112:115]
    s_waitcnt lgkmcnt(7)
    v_mfma_f32_16x16x32_bf16 v[112:115], v[64:67], v[88:91], v[112:115]
    v_mfma_f32_16x16x32_bf16 v[116:119], v[64:67], v[92:95], v[116:119]
    ds_read2_b64 v[64:67], v0 offset0:48 offset1:49
    s_waitcnt lgkmcnt(7)
    v_mfma_f32_16x16x32_bf16 v[116:119], v[68:71], v[88:91], v[116:119]
    v_mfma_f32_16x16x32_bf16 v[120:123], v[68:71], v[92:95], v[120:123]
    ds_read2_b64 v[68:71], v0 offset0:112 offset1:113
    s_waitcnt lgkmcnt(6)
    v_mfma_f32_16x16x32_bf16 v[120:123], v[72:75], v[88:91], v[120:123]
    v_mfma_f32_16x16x32_bf16 v[124:127], v[72:75], v[92:95], v[124:127]
    ds_read_b64 v[72:73], v11 offset:3456
    s_waitcnt lgkmcnt(5)
    v_mfma_f32_16x16x32_bf16 v[124:127], v[76:79], v[88:91], v[124:127]
    ds_read_b64 v[74:75], v11 offset:3464
    s_waitcnt lgkmcnt(5)
    v_mfma_f32_16x16x32_bf16 v[96:99], v[152:155], v[80:83], v[96:99]
    ds_read_b64 v[76:77], v11 offset:3968
    v_mfma_f32_16x16x32_bf16 v[100:103], v[184:187], v[80:83], v[100:103]
    ds_read_b64 v[78:79], v11 offset:3976
    s_waitcnt lgkmcnt(6)
    v_mfma_f32_16x16x32_bf16 v[100:103], v[152:155], v[84:87], v[100:103]
    ds_read_b128 v[88:91], v2 offset:4032
    v_mfma_f32_16x16x32_bf16 v[104:107], v[184:187], v[84:87], v[104:107]
    ds_read_b128 v[92:95], v2 offset:3520
    v_mfma_f32_16x16x32_bf16 v[104:107], v[216:219], v[80:83], v[104:107]
    v_mfma_f32_16x16x32_bf16 v[108:111], v[248:251], v[80:83], v[108:111]
    v_mfma_f32_16x16x32_bf16 v[108:111], v[216:219], v[84:87], v[108:111]
    v_mfma_f32_16x16x32_bf16 v[112:115], v[248:251], v[84:87], v[112:115]
    s_waitcnt lgkmcnt(7)
    v_mfma_f32_16x16x32_bf16 v[112:115], v[64:67], v[80:83], v[112:115]
    v_mfma_f32_16x16x32_bf16 v[116:119], v[64:67], v[84:87], v[116:119]
    ds_read2_b64 v[64:67], v0 offset0:56 offset1:57
    s_waitcnt lgkmcnt(7)
    v_mfma_f32_16x16x32_bf16 v[116:119], v[68:71], v[80:83], v[116:119]
    v_mfma_f32_16x16x32_bf16 v[120:123], v[68:71], v[84:87], v[120:123]
    ds_read2_b64 v[68:71], v0 offset0:120 offset1:121
    s_waitcnt lgkmcnt(6)
    v_mfma_f32_16x16x32_bf16 v[120:123], v[72:75], v[80:83], v[120:123]
    v_mfma_f32_16x16x32_bf16 v[124:127], v[72:75], v[84:87], v[124:127]
    ds_read_b64 v[72:73], v11 offset:3520
    s_waitcnt lgkmcnt(5)
    v_mfma_f32_16x16x32_bf16 v[124:127], v[76:79], v[80:83], v[124:127]
    ds_read_b64 v[74:75], v11 offset:3528
    s_waitcnt lgkmcnt(5)
    v_mfma_f32_16x16x32_bf16 v[96:99], v[156:159], v[88:91], v[96:99]
    ds_read_b64 v[76:77], v11 offset:4032
    v_mfma_f32_16x16x32_bf16 v[100:103], v[188:191], v[88:91], v[100:103]
    ds_read_b64 v[78:79], v11 offset:4040
    s_waitcnt lgkmcnt(6)
    v_mfma_f32_16x16x32_bf16 v[100:103], v[156:159], v[92:95], v[100:103]
    v_mfma_f32_16x16x32_bf16 v[104:107], v[188:191], v[92:95], v[104:107]
    v_mfma_f32_16x16x32_bf16 v[104:107], v[220:223], v[88:91], v[104:107]
    v_mfma_f32_16x16x32_bf16 v[108:111], v[252:255], v[88:91], v[108:111]
    v_mfma_f32_16x16x32_bf16 v[108:111], v[220:223], v[92:95], v[108:111]
    v_cvt_pk_bf16_f32 v80, v96, v97
    v_cvt_pk_bf16_f32 v81, v98, v99
    v_mfma_f32_16x16x32_bf16 v[112:115], v[252:255], v[92:95], v[112:115]
    ds_write_b64 v4, v[80:81] offset:0
    v_cvt_pk_bf16_f32 v82, v100, v101
    v_cvt_pk_bf16_f32 v83, v102, v103
    s_waitcnt lgkmcnt(6)
    v_mfma_f32_16x16x32_bf16 v[112:115], v[64:67], v[88:91], v[112:115]
    ds_write_b64 v4, v[82:83] offset:512
    v_mfma_f32_16x16x32_bf16 v[116:119], v[64:67], v[92:95], v[116:119]
    s_waitcnt lgkmcnt(6)
    v_mfma_f32_16x16x32_bf16 v[116:119], v[68:71], v[88:91], v[116:119]
    v_mfma_f32_16x16x32_bf16 v[120:123], v[68:71], v[92:95], v[120:123]
    s_waitcnt lgkmcnt(4)
    v_mfma_f32_16x16x32_bf16 v[120:123], v[72:75], v[88:91], v[120:123]
    v_mfma_f32_16x16x32_bf16 v[124:127], v[72:75], v[92:95], v[124:127]
    s_waitcnt lgkmcnt(2)
    v_mfma_f32_16x16x32_bf16 v[124:127], v[76:79], v[88:91], v[124:127]
    s_waitcnt lgkmcnt(0)
    s_barrier
    s_setprio 0
    s_cmp_eq_u32 s45, 0
    s_cbranch_scc1 L_B_S1
    v_add_u32 v6, 0x00100000, v6
    v_add_u32 v7, 0x00100000, v7
    global_load_dwordx4 v[36:39], v6, s[28:29]
    buffer_load_dwordx4 v[44:47], v7, s[48:51], 0 offen
    global_load_dwordx4 v[40:43], v6, s[30:31]
    s_waitcnt vmcnt(5)
    v_mov_b32_dpp v56, v48 row_shr:1 row_mask:0xf bank_mask:0xf
    v_mov_b32_dpp v57, v49 row_shr:1 row_mask:0xf bank_mask:0xf
    v_mov_b32_dpp v58, v50 row_shr:1 row_mask:0xf bank_mask:0xf
    v_mov_b32_dpp v59, v51 row_shr:1 row_mask:0xf bank_mask:0xf
    s_waitcnt vmcnt(4)
    v_mov_b32 v80, v52
    s_setprio 3
    v_mfma_f32_16x16x32_bf16 v[64:67], v[12:15], v[48:51], 0
    v_mfma_f32_16x16x32_bf16 v[68:71], v[16:19], v[48:51], 0
    v_mfma_f32_16x16x32_bf16 v[72:75], v[28:31], v[52:55], 0
    v_mfma_f32_16x16x32_bf16 v[64:67], v[20:23], v[56:59], v[64:67]
    v_mfma_f32_16x16x32_bf16 v[68:71], v[24:27], v[56:59], v[68:71]
    v_mfma_f32_16x16x32_bf16 v[76:79], v[32:35], v[52:55], 0
    s_setprio 0
    s_nop 4
    v_mul_f32 v64, v64, v72
    v_mul_f32 v65, v65, v73
    v_mul_f32 v66, v66, v74
    v_mul_f32 v67, v67, v75
    v_cvt_pk_bf16_f32 v80, v67, v66
    v_cvt_pk_bf16_f32 v81, v65, v64
    v_cvt_pk_bf16_f32 v82, v66, v65
    v_mul_f32 v68, v68, v76
    ds_write_b64 v3, v[80:81] offset:6114
    v_mul_f32 v69, v69, v77
    ds_write_b16 v3, v80 offset:1536
    v_mul_f32 v70, v70, v78
    v_mul_f32 v71, v71, v79
    ds_write_b32 v3, v82 offset:1538
    v_cvt_pk_bf16_f32 v84, v71, v70
    v_cvt_pk_bf16_f32 v85, v69, v68
    ds_write_b16_d16_hi v3, v81 offset:1542
    v_cvt_pk_bf16_f32 v86, v70, v69
    ds_write_b64 v3, v[84:85] offset:23986
    ds_write_b16 v3, v84 offset:19408
    ds_write_b32 v3, v86 offset:19410
    ds_write_b16_d16_hi v3, v85 offset:19414
    ds_read_b64_tr_b16 v[84:85], v5 offset:512
    ds_read_b64_tr_b16 v[86:87], v5 offset:8960
    s_waitcnt vmcnt(3)
    v_lshlrev_b32 v89, 16, v60
    v_and_b32 v60, 0xffff0000, v60
    s_waitcnt lgkmcnt(1)
    v_lshlrev_b32 v88, 16, v84
    v_and_b32 v84, 0xffff0000, v84
    v_mul_f32 v88, v88, v89
    v_mul_f32 v84, v84, v60
    v_cvt_pk_bf16_f32 v90, v88, v84
    v_lshlrev_b32 v89, 16, v61
    v_and_b32 v61, 0xffff0000, v61
    v_lshlrev_b32 v88, 16, v85
    v_and_b32 v85, 0xffff0000, v85
    v_mul_f32 v88, v88, v89
    v_mul_f32 v85, v85, v61
    v_cvt_pk_bf16_f32 v91, v88, v85
    v_lshlrev_b32 v89, 16, v62
    v_and_b32 v62, 0xffff0000, v62
    s_waitcnt lgkmcnt(0)
    v_lshlrev_b32 v88, 16, v86
    v_and_b32 v86, 0xffff0000, v86
    v_mul_f32 v88, v88, v89
    v_mul_f32 v86, v86, v62
    v_cvt_pk_bf16_f32 v92, v88, v86
    v_lshlrev_b32 v89, 16, v63
    v_and_b32 v63, 0xffff0000, v63
    v_lshlrev_b32 v88, 16, v87
    v_and_b32 v87, 0xffff0000, v87
    v_mul_f32 v88, v88, v89
    v_mul_f32 v87, v87, v63
    v_cvt_pk_bf16_f32 v93, v88, v87
    global_store_dwordx4 v9, v[90:93], s[38:39]
    v_add_u32 v8, 0x00100000, v8
    global_load_dwordx4 v[96:99], v8, s[26:27]
    s_branch L_B_M1
L_B_S1:
    v_add_u32 v6, 0x00200000, v6
    v_add_u32 v7, 0x00200000, v7
    global_load_dwordx4 v[36:39], v6, s[28:29]
    buffer_load_dwordx4 v[44:47], v7, s[48:51], 0 offen
    global_load_dwordx4 v[40:43], v6, s[30:31]
    v_add_u32 v6, 0x00100000, v6
    v_add_u32 v7, 0x00100000, v7
    global_load_dwordx4 v[48:51], v6, s[28:29]
    buffer_load_dwordx4 v[56:59], v7, s[48:51], 0 offen
    global_load_dwordx4 v[52:55], v6, s[30:31]
    global_load_dwordx4 v[60:63], v8, s[26:27]
    s_waitcnt vmcnt(5)
    v_mov_b32_dpp v44, v36 row_shr:1 row_mask:0xf bank_mask:0xf
    v_mov_b32_dpp v45, v37 row_shr:1 row_mask:0xf bank_mask:0xf
    v_mov_b32_dpp v46, v38 row_shr:1 row_mask:0xf bank_mask:0xf
    v_mov_b32_dpp v47, v39 row_shr:1 row_mask:0xf bank_mask:0xf
    s_waitcnt vmcnt(4)
    v_mov_b32 v80, v40
    s_setprio 3
    v_mfma_f32_16x16x32_bf16 v[64:67], v[12:15], v[36:39], 0
    v_mfma_f32_16x16x32_bf16 v[68:71], v[16:19], v[36:39], 0
    v_mfma_f32_16x16x32_bf16 v[72:75], v[28:31], v[40:43], 0
    v_mfma_f32_16x16x32_bf16 v[64:67], v[20:23], v[44:47], v[64:67]
    v_mfma_f32_16x16x32_bf16 v[68:71], v[24:27], v[44:47], v[68:71]
    v_mfma_f32_16x16x32_bf16 v[76:79], v[32:35], v[40:43], 0
    s_setprio 0
    s_nop 4
    v_mul_f32 v64, v64, v72
    v_mul_f32 v65, v65, v73
    v_mul_f32 v66, v66, v74
    v_mul_f32 v67, v67, v75
    v_cvt_pk_bf16_f32 v80, v67, v66
    v_cvt_pk_bf16_f32 v81, v65, v64
    v_cvt_pk_bf16_f32 v82, v66, v65
    v_mul_f32 v68, v68, v76
    ds_write_b64 v3, v[80:81] offset:6114
    v_mul_f32 v69, v69, v77
    ds_write_b16 v3, v80 offset:1536
    v_mul_f32 v70, v70, v78
    v_mul_f32 v71, v71, v79
    ds_write_b32 v3, v82 offset:1538
    v_cvt_pk_bf16_f32 v84, v71, v70
    v_cvt_pk_bf16_f32 v85, v69, v68
    ds_write_b16_d16_hi v3, v81 offset:1542
    v_cvt_pk_bf16_f32 v86, v70, v69
    ds_write_b64 v3, v[84:85] offset:23986
    ds_write_b16 v3, v84 offset:19408
    ds_write_b32 v3, v86 offset:19410
    ds_write_b16_d16_hi v3, v85 offset:19414
    s_waitcnt lgkmcnt(0)
L_B_M1:
    ds_read_b128 v[80:83], v2 offset:2560
    ds_read_b128 v[84:87], v2 offset:2048
    s_waitcnt lgkmcnt(1)
    v_mfma_f32_16x16x32_bf16 v[104:107], v[128:131], v[80:83], v[104:107]
    ds_read2_b64 v[64:67], v0 offset0:0 offset1:1
    v_mfma_f32_16x16x32_bf16 v[108:111], v[160:163], v[80:83], v[108:111]
    ds_read2_b64 v[68:71], v0 offset0:64 offset1:65
    s_waitcnt lgkmcnt(2)
    v_mfma_f32_16x16x32_bf16 v[108:111], v[128:131], v[84:87], v[108:111]
    ds_read_b128 v[88:91], v2 offset:2624
    v_mfma_f32_16x16x32_bf16 v[112:115], v[160:163], v[84:87], v[112:115]
    s_barrier
    s_setprio 2
    ds_read_b128 v[92:95], v2 offset:2112
    v_mfma_f32_16x16x32_bf16 v[112:115], v[192:195], v[80:83], v[112:115]
    v_mfma_f32_16x16x32_bf16 v[116:119], v[224:227], v[80:83], v[116:119]
    v_mfma_f32_16x16x32_bf16 v[116:119], v[192:195], v[84:87], v[116:119]
    v_mfma_f32_16x16x32_bf16 v[120:123], v[224:227], v[84:87], v[120:123]
    s_waitcnt lgkmcnt(3)
    v_mfma_f32_16x16x32_bf16 v[120:123], v[64:67], v[80:83], v[120:123]
    v_mfma_f32_16x16x32_bf16 v[124:127], v[64:67], v[84:87], v[124:127]
    ds_read2_b64 v[64:67], v0 offset0:8 offset1:9
    s_waitcnt lgkmcnt(3)
    v_mfma_f32_16x16x32_bf16 v[124:127], v[68:71], v[80:83], v[124:127]
    ds_read2_b64 v[68:71], v0 offset0:72 offset1:73
    s_waitcnt lgkmcnt(3)
    v_mfma_f32_16x16x32_bf16 v[104:107], v[132:135], v[88:91], v[104:107]
    ds_read_b128 v[80:83], v2 offset:2688
    v_mfma_f32_16x16x32_bf16 v[108:111], v[164:167], v[88:91], v[108:111]
    ds_read_b128 v[84:87], v2 offset:2176
    s_waitcnt lgkmcnt(4)
    v_mfma_f32_16x16x32_bf16 v[108:111], v[132:135], v[92:95], v[108:111]
    v_mfma_f32_16x16x32_bf16 v[112:115], v[164:167], v[92:95], v[112:115]
    v_mfma_f32_16x16x32_bf16 v[112:115], v[196:199], v[88:91], v[112:115]
    v_mfma_f32_16x16x32_bf16 v[116:119], v[228:231], v[88:91], v[116:119]
    v_mfma_f32_16x16x32_bf16 v[116:119], v[196:199], v[92:95], v[116:119]
    v_mfma_f32_16x16x32_bf16 v[120:123], v[228:231], v[92:95], v[120:123]
    s_waitcnt lgkmcnt(3)
    v_mfma_f32_16x16x32_bf16 v[120:123], v[64:67], v[88:91], v[120:123]
    v_mfma_f32_16x16x32_bf16 v[124:127], v[64:67], v[92:95], v[124:127]
    ds_read2_b64 v[64:67], v0 offset0:16 offset1:17
    s_waitcnt lgkmcnt(3)
    v_mfma_f32_16x16x32_bf16 v[124:127], v[68:71], v[88:91], v[124:127]
    ds_read2_b64 v[68:71], v0 offset0:80 offset1:81
    s_waitcnt lgkmcnt(3)
    v_mfma_f32_16x16x32_bf16 v[104:107], v[136:139], v[80:83], v[104:107]
    ds_read_b128 v[88:91], v2 offset:2752
    v_mfma_f32_16x16x32_bf16 v[108:111], v[168:171], v[80:83], v[108:111]
    ds_read_b128 v[92:95], v2 offset:2240
    s_waitcnt lgkmcnt(4)
    v_mfma_f32_16x16x32_bf16 v[108:111], v[136:139], v[84:87], v[108:111]
    v_mfma_f32_16x16x32_bf16 v[112:115], v[168:171], v[84:87], v[112:115]
    v_mfma_f32_16x16x32_bf16 v[112:115], v[200:203], v[80:83], v[112:115]
    v_mfma_f32_16x16x32_bf16 v[116:119], v[232:235], v[80:83], v[116:119]
    v_mfma_f32_16x16x32_bf16 v[116:119], v[200:203], v[84:87], v[116:119]
    v_mfma_f32_16x16x32_bf16 v[120:123], v[232:235], v[84:87], v[120:123]
    s_waitcnt lgkmcnt(3)
    v_mfma_f32_16x16x32_bf16 v[120:123], v[64:67], v[80:83], v[120:123]
    v_mfma_f32_16x16x32_bf16 v[124:127], v[64:67], v[84:87], v[124:127]
    ds_read2_b64 v[64:67], v0 offset0:24 offset1:25
    s_waitcnt lgkmcnt(3)
    v_mfma_f32_16x16x32_bf16 v[124:127], v[68:71], v[80:83], v[124:127]
    ds_read2_b64 v[68:71], v0 offset0:88 offset1:89
    s_waitcnt lgkmcnt(3)
    v_mfma_f32_16x16x32_bf16 v[104:107], v[140:143], v[88:91], v[104:107]
    ds_read_b128 v[80:83], v2 offset:2816
    v_mfma_f32_16x16x32_bf16 v[108:111], v[172:175], v[88:91], v[108:111]
    ds_read_b128 v[84:87], v2 offset:2304
    s_waitcnt lgkmcnt(4)
    v_mfma_f32_16x16x32_bf16 v[108:111], v[140:143], v[92:95], v[108:111]
    v_mfma_f32_16x16x32_bf16 v[112:115], v[172:175], v[92:95], v[112:115]
    v_mfma_f32_16x16x32_bf16 v[112:115], v[204:207], v[88:91], v[112:115]
    v_mfma_f32_16x16x32_bf16 v[116:119], v[236:239], v[88:91], v[116:119]
    v_mfma_f32_16x16x32_bf16 v[116:119], v[204:207], v[92:95], v[116:119]
    v_mfma_f32_16x16x32_bf16 v[120:123], v[236:239], v[92:95], v[120:123]
    s_waitcnt lgkmcnt(3)
    v_mfma_f32_16x16x32_bf16 v[120:123], v[64:67], v[88:91], v[120:123]
    v_mfma_f32_16x16x32_bf16 v[124:127], v[64:67], v[92:95], v[124:127]
    ds_read2_b64 v[64:67], v0 offset0:32 offset1:33
    s_waitcnt lgkmcnt(3)
    v_mfma_f32_16x16x32_bf16 v[124:127], v[68:71], v[88:91], v[124:127]
    ds_read2_b64 v[68:71], v0 offset0:96 offset1:97
    s_waitcnt lgkmcnt(3)
    v_mfma_f32_16x16x32_bf16 v[104:107], v[144:147], v[80:83], v[104:107]
    ds_read_b128 v[88:91], v2 offset:2880
    v_mfma_f32_16x16x32_bf16 v[108:111], v[176:179], v[80:83], v[108:111]
    ds_read_b128 v[92:95], v2 offset:2368
    s_waitcnt lgkmcnt(4)
    v_mfma_f32_16x16x32_bf16 v[108:111], v[144:147], v[84:87], v[108:111]
    v_mfma_f32_16x16x32_bf16 v[112:115], v[176:179], v[84:87], v[112:115]
    v_mfma_f32_16x16x32_bf16 v[112:115], v[208:211], v[80:83], v[112:115]
    v_mfma_f32_16x16x32_bf16 v[116:119], v[240:243], v[80:83], v[116:119]
    v_mfma_f32_16x16x32_bf16 v[116:119], v[208:211], v[84:87], v[116:119]
    v_mfma_f32_16x16x32_bf16 v[120:123], v[240:243], v[84:87], v[120:123]
    s_waitcnt lgkmcnt(3)
    v_mfma_f32_16x16x32_bf16 v[120:123], v[64:67], v[80:83], v[120:123]
    v_mfma_f32_16x16x32_bf16 v[124:127], v[64:67], v[84:87], v[124:127]
    ds_read2_b64 v[64:67], v0 offset0:40 offset1:41
    s_waitcnt lgkmcnt(3)
    v_mfma_f32_16x16x32_bf16 v[124:127], v[68:71], v[80:83], v[124:127]
    ds_read2_b64 v[68:71], v0 offset0:104 offset1:105
    s_waitcnt lgkmcnt(3)
    v_mfma_f32_16x16x32_bf16 v[104:107], v[148:151], v[88:91], v[104:107]
    ds_read_b128 v[80:83], v2 offset:2944
    v_mfma_f32_16x16x32_bf16 v[108:111], v[180:183], v[88:91], v[108:111]
    ds_read_b128 v[84:87], v2 offset:2432
    s_waitcnt lgkmcnt(4)
    v_mfma_f32_16x16x32_bf16 v[108:111], v[148:151], v[92:95], v[108:111]
    v_mfma_f32_16x16x32_bf16 v[112:115], v[180:183], v[92:95], v[112:115]
    v_mfma_f32_16x16x32_bf16 v[112:115], v[212:215], v[88:91], v[112:115]
    v_mfma_f32_16x16x32_bf16 v[116:119], v[244:247], v[88:91], v[116:119]
    v_mfma_f32_16x16x32_bf16 v[116:119], v[212:215], v[92:95], v[116:119]
    v_mfma_f32_16x16x32_bf16 v[120:123], v[244:247], v[92:95], v[120:123]
    s_waitcnt lgkmcnt(3)
    v_mfma_f32_16x16x32_bf16 v[120:123], v[64:67], v[88:91], v[120:123]
    v_mfma_f32_16x16x32_bf16 v[124:127], v[64:67], v[92:95], v[124:127]
    ds_read2_b64 v[64:67], v0 offset0:48 offset1:49
    s_waitcnt lgkmcnt(3)
    v_mfma_f32_16x16x32_bf16 v[124:127], v[68:71], v[88:91], v[124:127]
    ds_read2_b64 v[68:71], v0 offset0:112 offset1:113
    s_waitcnt lgkmcnt(3)
    v_mfma_f32_16x16x32_bf16 v[104:107], v[152:155], v[80:83], v[104:107]
    ds_read_b128 v[88:91], v2 offset:3008
    v_mfma_f32_16x16x32_bf16 v[108:111], v[184:187], v[80:83], v[108:111]
    ds_read_b128 v[92:95], v2 offset:2496
    s_waitcnt lgkmcnt(4)
    v_mfma_f32_16x16x32_bf16 v[108:111], v[152:155], v[84:87], v[108:111]
    v_mfma_f32_16x16x32_bf16 v[112:115], v[184:187], v[84:87], v[112:115]
    v_mfma_f32_16x16x32_bf16 v[112:115], v[216:219], v[80:83], v[112:115]
    v_mfma_f32_16x16x32_bf16 v[116:119], v[248:251], v[80:83], v[116:119]
    v_mfma_f32_16x16x32_bf16 v[116:119], v[216:219], v[84:87], v[116:119]
    v_mfma_f32_16x16x32_bf16 v[120:123], v[248:251], v[84:87], v[120:123]
    s_waitcnt lgkmcnt(3)
    v_mfma_f32_16x16x32_bf16 v[120:123], v[64:67], v[80:83], v[120:123]
    v_mfma_f32_16x16x32_bf16 v[124:127], v[64:67], v[84:87], v[124:127]
    ds_read2_b64 v[64:67], v0 offset0:56 offset1:57
    s_waitcnt lgkmcnt(3)
    v_mfma_f32_16x16x32_bf16 v[124:127], v[68:71], v[80:83], v[124:127]
    ds_read2_b64 v[68:71], v0 offset0:120 offset1:121
    s_waitcnt lgkmcnt(3)
    v_mfma_f32_16x16x32_bf16 v[104:107], v[156:159], v[88:91], v[104:107]
    v_mfma_f32_16x16x32_bf16 v[108:111], v[188:191], v[88:91], v[108:111]
    s_waitcnt lgkmcnt(2)
    v_mfma_f32_16x16x32_bf16 v[108:111], v[156:159], v[92:95], v[108:111]
    v_mfma_f32_16x16x32_bf16 v[112:115], v[188:191], v[92:95], v[112:115]
    v_mfma_f32_16x16x32_bf16 v[112:115], v[220:223], v[88:91], v[112:115]
    v_mfma_f32_16x16x32_bf16 v[116:119], v[252:255], v[88:91], v[116:119]
    v_mfma_f32_16x16x32_bf16 v[116:119], v[220:223], v[92:95], v[116:119]
    s_nop 0
    v_cvt_pk_bf16_f32 v80, v104, v105
    v_cvt_pk_bf16_f32 v81, v106, v107
    v_mfma_f32_16x16x32_bf16 v[120:123], v[252:255], v[92:95], v[120:123]
    ds_write_b64 v4, v[80:81] offset:1024
    v_cvt_pk_bf16_f32 v82, v108, v109
    v_cvt_pk_bf16_f32 v83, v110, v111
    s_waitcnt lgkmcnt(2)
    v_mfma_f32_16x16x32_bf16 v[120:123], v[64:67], v[88:91], v[120:123]
    ds_write_b64 v4, v[82:83] offset:1536
    v_mfma_f32_16x16x32_bf16 v[124:127], v[64:67], v[92:95], v[124:127]
    s_waitcnt lgkmcnt(2)
    v_mfma_f32_16x16x32_bf16 v[124:127], v[68:71], v[88:91], v[124:127]
    s_waitcnt lgkmcnt(0)
    s_barrier
    s_setprio 0
    s_cmp_eq_u32 s45, 0
    s_cbranch_scc1 L_B_S3
    v_add_u32 v8, 0x00100000, v8
    global_load_dwordx4 v[60:63], v8, s[26:27]
    s_waitcnt vmcnt(4)
    v_mov_b32_dpp v44, v36 row_shr:1 row_mask:0xf bank_mask:0xf
    v_mov_b32_dpp v45, v37 row_shr:1 row_mask:0xf bank_mask:0xf
    v_mov_b32_dpp v46, v38 row_shr:1 row_mask:0xf bank_mask:0xf
    v_mov_b32_dpp v47, v39 row_shr:1 row_mask:0xf bank_mask:0xf
    s_waitcnt vmcnt(3)
    v_mov_b32 v80, v40
    s_setprio 3
    v_mfma_f32_16x16x32_bf16 v[64:67], v[12:15], v[36:39], 0
    v_mfma_f32_16x16x32_bf16 v[68:71], v[16:19], v[36:39], 0
    v_mfma_f32_16x16x32_bf16 v[72:75], v[28:31], v[40:43], 0
    v_mfma_f32_16x16x32_bf16 v[64:67], v[20:23], v[44:47], v[64:67]
    v_mfma_f32_16x16x32_bf16 v[68:71], v[24:27], v[44:47], v[68:71]
    v_mfma_f32_16x16x32_bf16 v[76:79], v[32:35], v[40:43], 0
    s_setprio 0
    s_nop 4
    v_mul_f32 v64, v64, v72
    v_mul_f32 v65, v65, v73
    v_mul_f32 v66, v66, v74
    v_mul_f32 v67, v67, v75
    v_cvt_pk_bf16_f32 v80, v67, v66
    v_cvt_pk_bf16_f32 v81, v65, v64
    v_cvt_pk_bf16_f32 v82, v66, v65
    v_mul_f32 v68, v68, v76
    ds_write_b64 v3, v[80:81] offset:5090
    v_mul_f32 v69, v69, v77
    ds_write_b16 v3, v80 offset:512
    v_mul_f32 v70, v70, v78
    v_mul_f32 v71, v71, v79
    ds_write_b32 v3, v82 offset:514
    v_cvt_pk_bf16_f32 v84, v71, v70
    v_cvt_pk_bf16_f32 v85, v69, v68
    ds_write_b16_d16_hi v3, v81 offset:518
    v_cvt_pk_bf16_f32 v86, v70, v69
    ds_write_b64 v3, v[84:85] offset:22962
    ds_write_b16 v3, v84 offset:18384
    ds_write_b32 v3, v86 offset:18386
    ds_write_b16_d16_hi v3, v85 offset:18390
    ds_read_b64_tr_b16 v[84:85], v5 offset:1536
    ds_read_b64_tr_b16 v[86:87], v5 offset:9984
    v_add_u32 v9, 0x00200000, v9
    s_waitcnt vmcnt(1)
    v_lshlrev_b32 v89, 16, v96
    v_and_b32 v96, 0xffff0000, v96
    s_waitcnt lgkmcnt(1)
    v_lshlrev_b32 v88, 16, v84
    v_and_b32 v84, 0xffff0000, v84
    v_mul_f32 v88, v88, v89
    v_mul_f32 v84, v84, v96
    v_cvt_pk_bf16_f32 v90, v88, v84
    v_lshlrev_b32 v89, 16, v97
    v_and_b32 v97, 0xffff0000, v97
    v_lshlrev_b32 v88, 16, v85
    v_and_b32 v85, 0xffff0000, v85
    v_mul_f32 v88, v88, v89
    v_mul_f32 v85, v85, v97
    v_cvt_pk_bf16_f32 v91, v88, v85
    v_lshlrev_b32 v89, 16, v98
    v_and_b32 v98, 0xffff0000, v98
    s_waitcnt lgkmcnt(0)
    v_lshlrev_b32 v88, 16, v86
    v_and_b32 v86, 0xffff0000, v86
    v_mul_f32 v88, v88, v89
    v_mul_f32 v86, v86, v98
    v_cvt_pk_bf16_f32 v92, v88, v86
    v_lshlrev_b32 v89, 16, v99
    v_and_b32 v99, 0xffff0000, v99
    v_lshlrev_b32 v88, 16, v87
    v_and_b32 v87, 0xffff0000, v87
    v_mul_f32 v88, v88, v89
    v_mul_f32 v87, v87, v99
    v_cvt_pk_bf16_f32 v93, v88, v87
    global_store_dwordx4 v9, v[90:93], s[38:39]
    v_add_u32 v8, 0x00100000, v8
    global_load_dwordx4 v[100:103], v8, s[26:27]
    s_branch L_B_M2
L_B_S3:
    ds_read_b64_tr_b16 v[84:85], v5 offset:512
    ds_read_b64_tr_b16 v[86:87], v5 offset:8960
    s_waitcnt vmcnt(0)
    v_lshlrev_b32 v89, 16, v60
    v_and_b32 v60, 0xffff0000, v60
    s_waitcnt lgkmcnt(1)
    v_lshlrev_b32 v88, 16, v84
    v_and_b32 v84, 0xffff0000, v84
    v_mul_f32 v88, v88, v89
    v_mul_f32 v84, v84, v60
    v_cvt_pk_bf16_f32 v90, v88, v84
    v_lshlrev_b32 v89, 16, v61
    v_and_b32 v61, 0xffff0000, v61
    v_lshlrev_b32 v88, 16, v85
    v_and_b32 v85, 0xffff0000, v85
    v_mul_f32 v88, v88, v89
    v_mul_f32 v85, v85, v61
    v_cvt_pk_bf16_f32 v91, v88, v85
    v_lshlrev_b32 v89, 16, v62
    v_and_b32 v62, 0xffff0000, v62
    s_waitcnt lgkmcnt(0)
    v_lshlrev_b32 v88, 16, v86
    v_and_b32 v86, 0xffff0000, v86
    v_mul_f32 v88, v88, v89
    v_mul_f32 v86, v86, v62
    v_cvt_pk_bf16_f32 v92, v88, v86
    v_lshlrev_b32 v89, 16, v63
    v_and_b32 v63, 0xffff0000, v63
    v_lshlrev_b32 v88, 16, v87
    v_and_b32 v87, 0xffff0000, v87
    v_mul_f32 v88, v88, v89
    v_mul_f32 v87, v87, v63
    v_cvt_pk_bf16_f32 v93, v88, v87
    global_store_dwordx4 v9, v[90:93], s[38:39]
    v_mov_b32_dpp v56, v48 row_shr:1 row_mask:0xf bank_mask:0xf
    v_mov_b32_dpp v57, v49 row_shr:1 row_mask:0xf bank_mask:0xf
    v_mov_b32_dpp v58, v50 row_shr:1 row_mask:0xf bank_mask:0xf
    v_mov_b32_dpp v59, v51 row_shr:1 row_mask:0xf bank_mask:0xf
    v_mov_b32 v80, v52
    s_setprio 3
    v_mfma_f32_16x16x32_bf16 v[64:67], v[12:15], v[48:51], 0
    v_mfma_f32_16x16x32_bf16 v[68:71], v[16:19], v[48:51], 0
    v_mfma_f32_16x16x32_bf16 v[72:75], v[28:31], v[52:55], 0
    v_mfma_f32_16x16x32_bf16 v[64:67], v[20:23], v[56:59], v[64:67]
    v_mfma_f32_16x16x32_bf16 v[68:71], v[24:27], v[56:59], v[68:71]
    v_mfma_f32_16x16x32_bf16 v[76:79], v[32:35], v[52:55], 0
    s_setprio 0
    s_nop 4
    v_mul_f32 v64, v64, v72
    v_mul_f32 v65, v65, v73
    v_mul_f32 v66, v66, v74
    v_mul_f32 v67, v67, v75
    v_cvt_pk_bf16_f32 v80, v67, v66
    v_cvt_pk_bf16_f32 v81, v65, v64
    v_cvt_pk_bf16_f32 v82, v66, v65
    v_mul_f32 v68, v68, v76
    ds_write_b64 v3, v[80:81] offset:5090
    v_mul_f32 v69, v69, v77
    ds_write_b16 v3, v80 offset:512
    v_mul_f32 v70, v70, v78
    v_mul_f32 v71, v71, v79
    ds_write_b32 v3, v82 offset:514
    v_cvt_pk_bf16_f32 v84, v71, v70
    v_cvt_pk_bf16_f32 v85, v69, v68
    ds_write_b16_d16_hi v3, v81 offset:518
    v_cvt_pk_bf16_f32 v86, v70, v69
    ds_write_b64 v3, v[84:85] offset:22962
    ds_write_b16 v3, v84 offset:18384
    ds_write_b32 v3, v86 offset:18386
    ds_write_b16_d16_hi v3, v85 offset:18390
    v_add_u32 v8, 0x00100000, v8
    global_load_dwordx4 v[96:99], v8, s[26:27]
    v_add_u32 v8, 0x00100000, v8
    global_load_dwordx4 v[108:111], v8, s[26:27]
    s_waitcnt lgkmcnt(0)
L_B_M2:
    ds_read_b128 v[80:83], v2 offset:1536
    ds_read_b128 v[84:87], v2 offset:1024
    ds_read_b128 v[88:91], v2 offset:1600
    ds_read_b128 v[92:95], v2 offset:1088
    s_waitcnt lgkmcnt(3)
    v_mfma_f32_16x16x32_bf16 v[112:115], v[128:131], v[80:83], v[112:115]
    ds_read_b128 v[64:67], v2 offset:1664
    v_mfma_f32_16x16x32_bf16 v[116:119], v[160:163], v[80:83], v[116:119]
    ds_read_b128 v[68:71], v2 offset:1152
    s_waitcnt lgkmcnt(4)
    v_mfma_f32_16x16x32_bf16 v[116:119], v[128:131], v[84:87], v[116:119]
    v_mfma_f32_16x16x32_bf16 v[120:123], v[192:195], v[80:83], v[120:123]
    s_barrier
    s_setprio 2
    v_mfma_f32_16x16x32_bf16 v[124:127], v[224:227], v[80:83], v[124:127]
    s_waitcnt lgkmcnt(3)
    v_mfma_f32_16x16x32_bf16 v[112:115], v[132:135], v[88:91], v[112:115]
    ds_read_b128 v[72:75], v2 offset:1728
    v_mfma_f32_16x16x32_bf16 v[116:119], v[164:167], v[88:91], v[116:119]
    ds_read_b128 v[76:79], v2 offset:1216
    s_waitcnt lgkmcnt(4)
    v_mfma_f32_16x16x32_bf16 v[116:119], v[132:135], v[92:95], v[116:119]
    v_mfma_f32_16x16x32_bf16 v[120:123], v[196:199], v[88:91], v[120:123]
    v_mfma_f32_16x16x32_bf16 v[124:127], v[228:231], v[88:91], v[124:127]
    s_waitcnt lgkmcnt(3)
    v_mfma_f32_16x16x32_bf16 v[112:115], v[136:139], v[64:67], v[112:115]
    ds_read_b128 v[80:83], v2 offset:1792
    v_mfma_f32_16x16x32_bf16 v[116:119], v[168:171], v[64:67], v[116:119]
    ds_read_b128 v[84:87], v2 offset:1280
    s_waitcnt lgkmcnt(4)
    v_mfma_f32_16x16x32_bf16 v[116:119], v[136:139], v[68:71], v[116:119]
    v_mfma_f32_16x16x32_bf16 v[120:123], v[200:203], v[64:67], v[120:123]
    v_mfma_f32_16x16x32_bf16 v[124:127], v[232:235], v[64:67], v[124:127]
    s_waitcnt lgkmcnt(3)
    v_mfma_f32_16x16x32_bf16 v[112:115], v[140:143], v[72:75], v[112:115]
    ds_read_b128 v[88:91], v2 offset:1856
    v_mfma_f32_16x16x32_bf16 v[116:119], v[172:175], v[72:75], v[116:119]
    ds_read_b128 v[92:95], v2 offset:1344
    s_waitcnt lgkmcnt(4)
    v_mfma_f32_16x16x32_bf16 v[116:119], v[140:143], v[76:79], v[116:119]
    v_mfma_f32_16x16x32_bf16 v[120:123], v[204:207], v[72:75], v[120:123]
    v_mfma_f32_16x16x32_bf16 v[124:127], v[236:239], v[72:75], v[124:127]
    s_waitcnt lgkmcnt(3)
    v_mfma_f32_16x16x32_bf16 v[112:115], v[144:147], v[80:83], v[112:115]
    ds_read_b128 v[64:67], v2 offset:1920
    v_mfma_f32_16x16x32_bf16 v[116:119], v[176:179], v[80:83], v[116:119]
    ds_read_b128 v[68:71], v2 offset:1408
    s_waitcnt lgkmcnt(4)
    v_mfma_f32_16x16x32_bf16 v[116:119], v[144:147], v[84:87], v[116:119]
    v_mfma_f32_16x16x32_bf16 v[120:123], v[208:211], v[80:83], v[120:123]
    v_mfma_f32_16x16x32_bf16 v[124:127], v[240:243], v[80:83], v[124:127]
    s_waitcnt lgkmcnt(3)
    v_mfma_f32_16x16x32_bf16 v[112:115], v[148:151], v[88:91], v[112:115]
    ds_read_b128 v[72:75], v2 offset:1984
    v_mfma_f32_16x16x32_bf16 v[116:119], v[180:183], v[88:91], v[116:119]
    ds_read_b128 v[76:79], v2 offset:1472
    s_waitcnt lgkmcnt(4)
    v_mfma_f32_16x16x32_bf16 v[116:119], v[148:151], v[92:95], v[116:119]
    v_mfma_f32_16x16x32_bf16 v[120:123], v[212:215], v[88:91], v[120:123]
    v_mfma_f32_16x16x32_bf16 v[124:127], v[244:247], v[88:91], v[124:127]
    s_waitcnt lgkmcnt(3)
    v_mfma_f32_16x16x32_bf16 v[112:115], v[152:155], v[64:67], v[112:115]
    v_mfma_f32_16x16x32_bf16 v[116:119], v[184:187], v[64:67], v[116:119]
    s_waitcnt lgkmcnt(2)
    v_mfma_f32_16x16x32_bf16 v[116:119], v[152:155], v[68:71], v[116:119]
    v_mfma_f32_16x16x32_bf16 v[120:123], v[216:219], v[64:67], v[120:123]
    v_mfma_f32_16x16x32_bf16 v[124:127], v[248:251], v[64:67], v[124:127]
    s_waitcnt lgkmcnt(1)
    v_mfma_f32_16x16x32_bf16 v[112:115], v[156:159], v[72:75], v[112:115]
    v_mfma_f32_16x16x32_bf16 v[116:119], v[188:191], v[72:75], v[116:119]
    s_waitcnt lgkmcnt(0)
    v_mfma_f32_16x16x32_bf16 v[116:119], v[156:159], v[76:79], v[116:119]
    v_mfma_f32_16x16x32_bf16 v[120:123], v[220:223], v[72:75], v[120:123]
    v_mfma_f32_16x16x32_bf16 v[124:127], v[252:255], v[72:75], v[124:127]
    s_nop 2
    v_cvt_pk_bf16_f32 v80, v112, v113
    v_cvt_pk_bf16_f32 v81, v114, v115
    ds_write_b64 v4, v[80:81] offset:0
    v_cvt_pk_bf16_f32 v82, v116, v117
    v_cvt_pk_bf16_f32 v83, v118, v119
    ds_write_b64 v4, v[82:83] offset:512
    s_waitcnt lgkmcnt(0)
    s_barrier
    s_setprio 0
    s_cmp_eq_u32 s45, 0
    s_cbranch_scc1 L_B_S5
    ds_read_b64_tr_b16 v[84:85], v5 offset:512
    ds_read_b64_tr_b16 v[86:87], v5 offset:8960
    v_add_u32 v9, 0x00200000, v9
    s_waitcnt vmcnt(2)
    v_lshlrev_b32 v89, 16, v60
    v_and_b32 v60, 0xffff0000, v60
    s_waitcnt lgkmcnt(1)
    v_lshlrev_b32 v88, 16, v84
    v_and_b32 v84, 0xffff0000, v84
    v_mul_f32 v88, v88, v89
    v_mul_f32 v84, v84, v60
    v_cvt_pk_bf16_f32 v90, v88, v84
    v_lshlrev_b32 v89, 16, v61
    v_and_b32 v61, 0xffff0000, v61
    v_lshlrev_b32 v88, 16, v85
    v_and_b32 v85, 0xffff0000, v85
    v_mul_f32 v88, v88, v89
    v_mul_f32 v85, v85, v61
    v_cvt_pk_bf16_f32 v91, v88, v85
    v_lshlrev_b32 v89, 16, v62
    v_and_b32 v62, 0xffff0000, v62
    s_waitcnt lgkmcnt(0)
    v_lshlrev_b32 v88, 16, v86
    v_and_b32 v86, 0xffff0000, v86
    v_mul_f32 v88, v88, v89
    v_mul_f32 v86, v86, v62
    v_cvt_pk_bf16_f32 v92, v88, v86
    v_lshlrev_b32 v89, 16, v63
    v_and_b32 v63, 0xffff0000, v63
    v_lshlrev_b32 v88, 16, v87
    v_and_b32 v87, 0xffff0000, v87
    v_mul_f32 v88, v88, v89
    v_mul_f32 v87, v87, v63
    v_cvt_pk_bf16_f32 v93, v88, v87
    global_store_dwordx4 v9, v[90:93], s[38:39]
    s_nop 1
    v_add_u32 v9, 0x00200000, v9
    s_branch L_B_M3
L_B_S5:
    v_add_u32 v8, 0x00100000, v8
    global_load_dwordx4 v[100:103], v8, s[26:27]
    ds_read_b64_tr_b16 v[84:85], v5 offset:1536
    ds_read_b64_tr_b16 v[86:87], v5 offset:9984
    v_add_u32 v9, 0x00200000, v9
    s_waitcnt vmcnt(2)
    v_lshlrev_b32 v89, 16, v96
    v_and_b32 v96, 0xffff0000, v96
    s_waitcnt lgkmcnt(1)
    v_lshlrev_b32 v88, 16, v84
    v_and_b32 v84, 0xffff0000, v84
    v_mul_f32 v88, v88, v89
    v_mul_f32 v84, v84, v96
    v_cvt_pk_bf16_f32 v90, v88, v84
    v_lshlrev_b32 v89, 16, v97
    v_and_b32 v97, 0xffff0000, v97
    v_lshlrev_b32 v88, 16, v85
    v_and_b32 v85, 0xffff0000, v85
    v_mul_f32 v88, v88, v89
    v_mul_f32 v85, v85, v97
    v_cvt_pk_bf16_f32 v91, v88, v85
    v_lshlrev_b32 v89, 16, v98
    v_and_b32 v98, 0xffff0000, v98
    s_waitcnt lgkmcnt(0)
    v_lshlrev_b32 v88, 16, v86
    v_and_b32 v86, 0xffff0000, v86
    v_mul_f32 v88, v88, v89
    v_mul_f32 v86, v86, v98
    v_cvt_pk_bf16_f32 v92, v88, v86
    v_lshlrev_b32 v89, 16, v99
    v_and_b32 v99, 0xffff0000, v99
    v_lshlrev_b32 v88, 16, v87
    v_and_b32 v87, 0xffff0000, v87
    v_mul_f32 v88, v88, v89
    v_mul_f32 v87, v87, v99
    v_cvt_pk_bf16_f32 v93, v88, v87
    global_store_dwordx4 v9, v[90:93], s[38:39]
L_B_M3:
    ds_read_b128 v[64:67], v2 offset:1024
    ds_read_b128 v[68:71], v2 offset:512
    ds_read_b128 v[72:75], v2 offset:0
    ds_read_b128 v[76:79], v2 offset:1088
    ds_read_b128 v[80:83], v2 offset:576
    ds_read_b128 v[84:87], v2 offset:64
    s_waitcnt lgkmcnt(4)
    v_mfma_f32_16x16x32_bf16 v[120:123], v[128:131], v[68:71], v[120:123]
    ds_read_b128 v[36:39], v2 offset:1152
    v_mfma_f32_16x16x32_bf16 v[120:123], v[160:163], v[64:67], v[120:123]
    ds_read_b128 v[40:43], v2 offset:640
    v_mfma_f32_16x16x32_bf16 v[124:127], v[192:195], v[64:67], v[124:127]
    ds_read_b128 v[44:47], v2 offset:128
    v_mfma_f32_16x16x32_bf16 v[124:127], v[160:163], v[68:71], v[124:127]
    s_barrier
    s_setprio 2
    s_waitcnt lgkmcnt(6)
    v_mfma_f32_16x16x32_bf16 v[124:127], v[128:131], v[72:75], v[124:127]
    s_waitcnt lgkmcnt(4)
    v_mfma_f32_16x16x32_bf16 v[120:123], v[132:135], v[80:83], v[120:123]
    ds_read_b128 v[64:67], v2 offset:1216
    v_mfma_f32_16x16x32_bf16 v[120:123], v[164:167], v[76:79], v[120:123]
    ds_read_b128 v[68:71], v2 offset:704
    v_mfma_f32_16x16x32_bf16 v[124:127], v[196:199], v[76:79], v[124:127]
    ds_read_b128 v[72:75], v2 offset:192
    v_mfma_f32_16x16x32_bf16 v[124:127], v[164:167], v[80:83], v[124:127]
    s_waitcnt lgkmcnt(6)
    v_mfma_f32_16x16x32_bf16 v[124:127], v[132:135], v[84:87], v[124:127]
    s_waitcnt lgkmcnt(4)
    v_mfma_f32_16x16x32_bf16 v[120:123], v[136:139], v[40:43], v[120:123]
    ds_read_b128 v[76:79], v2 offset:1280
    v_mfma_f32_16x16x32_bf16 v[120:123], v[168:171], v[36:39], v[120:123]
    ds_read_b128 v[80:83], v2 offset:768
    v_mfma_f32_16x16x32_bf16 v[124:127], v[200:203], v[36:39], v[124:127]
    ds_read_b128 v[84:87], v2 offset:256
    v_mfma_f32_16x16x32_bf16 v[124:127], v[168:171], v[40:43], v[124:127]
    s_waitcnt lgkmcnt(6)
    v_mfma_f32_16x16x32_bf16 v[124:127], v[136:139], v[44:47], v[124:127]
    s_waitcnt lgkmcnt(4)
    v_mfma_f32_16x16x32_bf16 v[120:123], v[140:143], v[68:71], v[120:123]
    ds_read_b128 v[36:39], v2 offset:1344
    v_mfma_f32_16x16x32_bf16 v[120:123], v[172:175], v[64:67], v[120:123]
    ds_read_b128 v[40:43], v2 offset:832
    v_mfma_f32_16x16x32_bf16 v[124:127], v[204:207], v[64:67], v[124:127]
    ds_read_b128 v[44:47], v2 offset:320
    v_mfma_f32_16x16x32_bf16 v[124:127], v[172:175], v[68:71], v[124:127]
    s_waitcnt lgkmcnt(6)
    v_mfma_f32_16x16x32_bf16 v[124:127], v[140:143], v[72:75], v[124:127]
    s_waitcnt lgkmcnt(4)
    v_mfma_f32_16x16x32_bf16 v[120:123], v[144:147], v[80:83], v[120:123]
    ds_read_b128 v[64:67], v2 offset:1408
    v_mfma_f32_16x16x32_bf16 v[120:123], v[176:179], v[76:79], v[120:123]
    ds_read_b128 v[68:71], v2 offset:896
    v_mfma_f32_16x16x32_bf16 v[124:127], v[208:211], v[76:79], v[124:127]
    ds_read_b128 v[72:75], v2 offset:384
    v_mfma_f32_16x16x32_bf16 v[124:127], v[176:179], v[80:83], v[124:127]
    s_waitcnt lgkmcnt(6)
    v_mfma_f32_16x16x32_bf16 v[124:127], v[144:147], v[84:87], v[124:127]
    s_waitcnt lgkmcnt(4)
    v_mfma_f32_16x16x32_bf16 v[120:123], v[148:151], v[40:43], v[120:123]
    ds_read_b128 v[76:79], v2 offset:1472
    v_mfma_f32_16x16x32_bf16 v[120:123], v[180:183], v[36:39], v[120:123]
    ds_read_b128 v[80:83], v2 offset:960
    v_mfma_f32_16x16x32_bf16 v[124:127], v[212:215], v[36:39], v[124:127]
    ds_read_b128 v[84:87], v2 offset:448
    v_mfma_f32_16x16x32_bf16 v[124:127], v[180:183], v[40:43], v[124:127]
    s_waitcnt lgkmcnt(6)
    v_mfma_f32_16x16x32_bf16 v[124:127], v[148:151], v[44:47], v[124:127]
    s_waitcnt lgkmcnt(4)
    v_mfma_f32_16x16x32_bf16 v[120:123], v[152:155], v[68:71], v[120:123]
    v_mfma_f32_16x16x32_bf16 v[120:123], v[184:187], v[64:67], v[120:123]
    v_mfma_f32_16x16x32_bf16 v[124:127], v[216:219], v[64:67], v[124:127]
    v_mfma_f32_16x16x32_bf16 v[124:127], v[184:187], v[68:71], v[124:127]
    s_waitcnt lgkmcnt(3)
    v_mfma_f32_16x16x32_bf16 v[124:127], v[152:155], v[72:75], v[124:127]
    s_waitcnt lgkmcnt(1)
    v_mfma_f32_16x16x32_bf16 v[120:123], v[156:159], v[80:83], v[120:123]
    v_mfma_f32_16x16x32_bf16 v[120:123], v[188:191], v[76:79], v[120:123]
    v_mfma_f32_16x16x32_bf16 v[124:127], v[220:223], v[76:79], v[124:127]
    v_mfma_f32_16x16x32_bf16 v[124:127], v[188:191], v[80:83], v[124:127]
    s_waitcnt lgkmcnt(0)
    v_mfma_f32_16x16x32_bf16 v[124:127], v[156:159], v[84:87], v[124:127]
    s_nop 3
    v_cvt_pk_bf16_f32 v36, v120, v121
    v_cvt_pk_bf16_f32 v37, v122, v123
    ds_write_b64 v4, v[36:37] offset:1024
    s_nop 0
    v_cvt_pk_bf16_f32 v38, v124, v125
    v_cvt_pk_bf16_f32 v39, v126, v127
    ds_write_b64 v4, v[38:39] offset:1536
    s_waitcnt lgkmcnt(0)
    s_barrier
    s_setprio 0
    s_cmp_lg_u32 s45, 0
    s_cbranch_scc1 L_B_F
    ds_read_b64_tr_b16 v[84:85], v5 offset:512
    ds_read_b64_tr_b16 v[86:87], v5 offset:8960
    v_add_u32 v9, 0x00200000, v9
    s_waitcnt vmcnt(2)
    v_lshlrev_b32 v89, 16, v108
    v_and_b32 v108, 0xffff0000, v108
    s_waitcnt lgkmcnt(1)
    v_lshlrev_b32 v88, 16, v84
    v_and_b32 v84, 0xffff0000, v84
    v_mul_f32 v88, v88, v89
    v_mul_f32 v84, v84, v108
    v_cvt_pk_bf16_f32 v90, v88, v84
    v_lshlrev_b32 v89, 16, v109
    v_and_b32 v109, 0xffff0000, v109
    v_lshlrev_b32 v88, 16, v85
    v_and_b32 v85, 0xffff0000, v85
    v_mul_f32 v88, v88, v89
    v_mul_f32 v85, v85, v109
    v_cvt_pk_bf16_f32 v91, v88, v85
    v_lshlrev_b32 v89, 16, v110
    v_and_b32 v110, 0xffff0000, v110
    s_waitcnt lgkmcnt(0)
    v_lshlrev_b32 v88, 16, v86
    v_and_b32 v86, 0xffff0000, v86
    v_mul_f32 v88, v88, v89
    v_mul_f32 v86, v86, v110
    v_cvt_pk_bf16_f32 v92, v88, v86
    v_lshlrev_b32 v89, 16, v111
    v_and_b32 v111, 0xffff0000, v111
    v_lshlrev_b32 v88, 16, v87
    v_and_b32 v87, 0xffff0000, v87
    v_mul_f32 v88, v88, v89
    v_mul_f32 v87, v87, v111
    v_cvt_pk_bf16_f32 v93, v88, v87
    global_store_dwordx4 v9, v[90:93], s[38:39]
    s_barrier
    s_nop 0
    v_add_u32 v9, 0x00200000, v9
L_B_F:
    s_waitcnt vmcnt(1)
    ds_read_b64_tr_b16 v[64:65], v5 offset:1536
    ds_read_b64_tr_b16 v[66:67], v5 offset:9984
    v_lshlrev_b32 v69, 16, v100
    v_and_b32 v100, 0xffff0000, v100
    s_waitcnt lgkmcnt(1)
    v_lshlrev_b32 v68, 16, v64
    v_and_b32 v64, 0xffff0000, v64
    v_mul_f32 v68, v68, v69
    v_mul_f32 v64, v64, v100
    v_cvt_pk_bf16_f32 v70, v68, v64
    v_lshlrev_b32 v69, 16, v101
    v_and_b32 v101, 0xffff0000, v101
    v_lshlrev_b32 v68, 16, v65
    v_and_b32 v65, 0xffff0000, v65
    v_mul_f32 v68, v68, v69
    v_mul_f32 v65, v65, v101
    v_cvt_pk_bf16_f32 v71, v68, v65
    v_lshlrev_b32 v69, 16, v102
    v_and_b32 v102, 0xffff0000, v102
    s_waitcnt lgkmcnt(0)
    v_lshlrev_b32 v68, 16, v66
    v_and_b32 v66, 0xffff0000, v66
    v_mul_f32 v68, v68, v69
    v_mul_f32 v66, v66, v102
    v_cvt_pk_bf16_f32 v72, v68, v66
    v_lshlrev_b32 v69, 16, v103
    v_and_b32 v103, 0xffff0000, v103
    v_lshlrev_b32 v68, 16, v67
    v_and_b32 v67, 0xffff0000, v67
    v_mul_f32 v68, v68, v69
    v_mul_f32 v67, v67, v103
    v_cvt_pk_bf16_f32 v73, v68, v67
    global_store_dwordx4 v9, v[70:73], s[38:39]
    s_endpgm
L_exit:
    s_endpgm
.section .rodata,"a"
.p2align 6
.amdhsa_kernel concat_heads__ssm_conv_s4__ssm_conv_h3__prompt_kernel
  .amdhsa_next_free_vgpr 256
  .amdhsa_next_free_sgpr 102
  .amdhsa_accum_offset 256
  .amdhsa_group_segment_fixed_size 0
  .amdhsa_kernarg_size 144
  .amdhsa_user_sgpr_count 2
  .amdhsa_user_sgpr_kernarg_segment_ptr 1
  .amdhsa_system_sgpr_workgroup_id_x 1
.end_amdhsa_kernel
```
